```python
import torch

def _softmax(x, axis=-1):
    return torch.softmax(x, dim=axis)
def _gelu(x):
    return torch.nn.functional.gelu(x, approximate="tanh")
def _silu(x):
    return torch.nn.functional.silu(x)
def _sigmoid(x):
    return torch.sigmoid(x)
def _layernorm(x, axis=-1, eps=1e-5):
    m = x.mean(dim=axis, keepdim=True)
    v = x.var(dim=axis, keepdim=True, unbiased=False)
    return (x - m) / torch.sqrt(v + eps)
def _scatter_add(tgt, idx, src, axis=0):
    return tgt.clone().index_add_(axis, idx, src)
def _segment_sum(src, seg, n):
    out = torch.zeros((n,) + src.shape[1:], dtype=src.dtype)
    return out.index_add_(0, seg, src)
def _pad(x, pw):
    flat = tuple(v for pair in reversed(pw) for v in pair)
    return torch.nn.functional.pad(x, flat)

kernel_name = 'gated_mix__mha_block__dense_activation_relu__prompt'

def setup_inputs():

    _w = (lambda a: (lambda t: t.to(torch.bfloat16) if t.is_floating_point() else t)(torch.as_tensor(a)))
    def _A_setup():
        B, S, D, H = 1, 2048, 640, 32
        return {
            "x": _w((lambda *s: torch.randn(*s, dtype=torch.bfloat16) * 0.05)(B, S, D)),
            "wqkv": _w((lambda *s: torch.randn(*s, dtype=torch.bfloat16) * 0.8)(D, 3 * D)),
            "wo": _w((lambda *s: torch.randn(*s, dtype=torch.bfloat16) * 0.2)(D, D)),
        }
    _A_in = _A_setup()

    def _B_setup():
        B, S, D, Dff = 1, 2048, 640, 1536
        return {
            "x": _w((lambda *s: torch.randn(*s, dtype=torch.bfloat16) * 0.05)(B, S, D)),
            "w1": _w((lambda *s: torch.randn(*s, dtype=torch.bfloat16) * 0.05)(D, Dff)),
            "w2": _w((lambda *s: torch.randn(*s, dtype=torch.bfloat16) * 0.05)(Dff, D)),
        }
    _B_in = _B_setup()

    return {
        "A_x": _A_in["x"],
        "A_wqkv": _A_in["wqkv"],
        "A_wo": _A_in["wo"],
        "B_x": _B_in["x"],
        "B_w1": _B_in["w1"],
        "B_w2": _B_in["w2"],
        "gate_w": _w((lambda *s: torch.randn(*s, dtype=torch.bfloat16) * 0.05)(640) * 16.0),
    }

def reference(A_x, A_wqkv, A_wo, B_x, B_w1, B_w2, gate_w):
    def _A_ref(x, wqkv, wo):
        B, S, D = x.shape
        H = 32
        Dh = D // H
        qkv = (lambda x, *d: x.permute(*d))((x @ wqkv).reshape(B, S, 3, H, Dh), 2, 0, 3, 1, 4)
        q, k, v = qkv[0], qkv[1], qkv[2]
        scores = torch.einsum("bhqd,bhkd->bhqk", q, k) * (Dh ** -0.5)
        p = _softmax(scores, axis=-1)
        o = torch.einsum("bhqk,bhkd->bhqd", p, v)
        return (lambda x, *d: x.permute(*d))(o, 0, 2, 1, 3).reshape(B, S, D) @ wo

    def _B_ref(x, w1, w2):
        h = torch.einsum("bsd,df->bsf", x, w1)
        zero = torch.zeros_like(h)
        h = torch.maximum(h, zero)
        return torch.einsum("bsf,fd->bsd", h, w2)

    x = A_x
    g = _sigmoid((x * gate_w).sum(-1, keepdims=True))
    a = _A_ref(x, A_wqkv, A_wo)
    b = _B_ref(x, B_w1, B_w2)
    return g * a + (1 - g) * b
```

```asm
; @launch grid=(256,1,1) block=(512,1,1) lds=163840
.amdgcn_target "amdgcn-amd-amdhsa--gfx950"
.text
.globl gated_mix__mha_block__dense_activation_relu__prompt_kernel
.p2align 8
.type gated_mix__mha_block__dense_activation_relu__prompt_kernel,@function
gated_mix__mha_block__dense_activation_relu__prompt_kernel:
  s_cmp_ge_u32 s2, 256
  s_cbranch_scc1 L_end
  s_load_dwordx2 s[28:29], s[0:1], 0
  s_load_dwordx2 s[32:33], s[0:1], 8
  s_load_dwordx4 s[12:15], s[0:1], 32
  s_load_dwordx8 s[16:23], s[0:1], 48
  s_load_dwordx2 s[8:9], s[0:1], 16
  s_getpc_b64 s[52:53]
L_pc:
  s_lshr_b32 s54, s2, 3
  v_lshrrev_b32 v163, 4, v0
  s_lshl_b32 s54, s54, 11
  v_lshl_add_u32 v163, v163, 6, s54
  v_min_u32 v163, L_last-L_pc, v163
  global_load_dword v163, v163, s[52:53]
  v_lshrrev_b32 v1, 6, v0
  v_and_b32 v0, 63, v0
  s_and_b32 s52, s2, 7
  v_readfirstlane_b32 s44, v1
  s_lshr_b32 s53, s2, 3
  s_and_b32 s49, s53, 7
  s_lshr_b32 s55, s53, 3
  s_and_b32 s54, s52, 1
  s_lshl3_add_u32 s45, s54, s49
  s_and_b32 s54, s52, 6
  s_lshl1_add_u32 s46, s54, s55
  s_cmp_lt_u32 s44, 4
  s_cbranch_scc1 L_cons
  s_sub_u32 s56, s44, 4
  v_lshrrev_b32 v192, 3, v0
  v_mul_u32_u24 v192, 1280, v192
  v_and_b32 v193, 7, v0
  v_lshrrev_b32 v194, 4, v0
  v_xor_b32 v193, v193, v194
  v_lshl_add_u32 v164, v193, 4, v192
  v_xor_b32 v193, 64, v164
  v_add_u32 v165, 9216, v193
  v_add_u32 v166, 18432, v164
  v_add_u32 v167, 27648, v193
  s_lshl2_add_u32 s52, s45, s56
  s_mul_i32 s10, s52, 40960
  s_lshl_b32 s52, s55, 2
  s_lshr_b32 s52, 21520, s52
  s_and_b32 s52, s52, 15
  s_add_u32 s52, s52, s49
  s_cmp_ge_u32 s52, 10
  s_cselect_b32 s53, 10, 0
  s_sub_u32 s11, s52, s53
  s_lshl_b32 s52, s11, 7
  s_add_u32 s57, s10, s52
  s_lshl_b32 s59, s56, 12
  s_mov_b32 s30, 0x280000
  s_mov_b32 s31, 0x20000
  s_add_u32 m0, s59, 0
  s_waitcnt lgkmcnt(0)
  buffer_load_dwordx4 v164, s[28:31], s57 offen offset:0 lds
  buffer_load_dwordx4 v165, s[28:31], s57 offen offset:1024 lds
  buffer_load_dwordx4 v166, s[28:31], s57 offen offset:2048 lds
  buffer_load_dwordx4 v167, s[28:31], s57 offen offset:3072 lds
  v_and_b32 v192, 15, v0
  v_lshlrev_b32 v193, 1, v194
  v_xor_b32 v192, v192, v193
  v_mul_u32_u24 v193, 3840, v194
  v_lshl_add_u32 v168, v192, 4, v193
  v_xor_b32 v192, 8, v192
  v_lshl_add_u32 v192, v192, 4, v193
  v_add_u32 v169, 14336, v168
  v_add_u32 v170, 28672, v192
  v_add_u32 v171, 43008, v192
  s_mul_i32 s52, s56, 61440
  s_lshl_b32 s53, s46, 8
  s_add_u32 s61, s52, s53
  s_mul_i32 s52, s11, 245760
  s_add_u32 s58, s61, s52
  s_cmp_eq_u32 s46, 15
  s_cselect_b32 s34, 0, 0x258000
  s_mov_b32 s35, s31
  s_add_u32 m0, m0, 16384
  s_nop 0
  buffer_load_dwordx4 v168, s[32:35], s58 offen offset:0 lds
  buffer_load_dwordx4 v169, s[32:35], s58 offen offset:1024 lds
  buffer_load_dwordx4 v170, s[32:35], s58 offen offset:2048 lds
  buffer_load_dwordx4 v171, s[32:35], s58 offen offset:3072 lds
  s_add_u32 s11, s11, 2
  s_cmp_ge_u32 s11, 10
  s_cselect_b32 s53, 10, 0
  s_sub_u32 s11, s11, s53
  s_lshl_b32 s52, s11, 7
  s_add_u32 s57, s10, s52
  s_mul_i32 s52, s11, 245760
  s_add_u32 s58, s61, s52
  s_add_u32 m0, s59, 32768
  s_nop 0
  buffer_load_dwordx4 v164, s[28:31], s57 offen offset:0 lds
  buffer_load_dwordx4 v165, s[28:31], s57 offen offset:1024 lds
  buffer_load_dwordx4 v166, s[28:31], s57 offen offset:2048 lds
  buffer_load_dwordx4 v167, s[28:31], s57 offen offset:3072 lds
  s_add_u32 m0, m0, 16384
  s_nop 0
  buffer_load_dwordx4 v168, s[32:35], s58 offen offset:0 lds
  buffer_load_dwordx4 v169, s[32:35], s58 offen offset:1024 lds
  buffer_load_dwordx4 v170, s[32:35], s58 offen offset:2048 lds
  buffer_load_dwordx4 v171, s[32:35], s58 offen offset:3072 lds
  s_add_u32 s11, s11, 2
  s_cmp_ge_u32 s11, 10
  s_cselect_b32 s53, 10, 0
  s_sub_u32 s11, s11, s53
  s_lshl_b32 s52, s11, 7
  s_add_u32 s57, s10, s52
  s_mul_i32 s52, s11, 245760
  s_add_u32 s58, s61, s52
  s_mov_b32 s24, s22
  s_mov_b32 s25, s23
  s_mov_b32 s26, 0x1400000
  s_mov_b32 s27, 0x20000
  v_add_u32 v192, 0, v0
  v_mul_u32_u24 v193, 5462, v192
  v_lshrrev_b32 v193, 16, v193
  v_mul_u32_u24 v194, 12, v193
  v_sub_u32 v194, v192, v194
  v_bfe_u32 v195, v193, 3, 1
  v_lshlrev_b32 v195, 1, v195
  v_xor_b32 v194, v194, v195
  v_mul_u32_u24 v193, 3072, v193
  v_lshl_add_u32 v249, v194, 4, v193
  v_add_u32 v192, 64, v0
  v_mul_u32_u24 v193, 5462, v192
  v_lshrrev_b32 v193, 16, v193
  v_mul_u32_u24 v194, 12, v193
  v_sub_u32 v194, v192, v194
  v_bfe_u32 v195, v193, 3, 1
  v_lshlrev_b32 v195, 1, v195
  v_xor_b32 v194, v194, v195
  v_mul_u32_u24 v193, 3072, v193
  v_lshl_add_u32 v255, v194, 4, v193
  v_add_u32 v192, 128, v0
  v_mul_u32_u24 v193, 5462, v192
  v_lshrrev_b32 v193, 16, v193
  v_mul_u32_u24 v194, 12, v193
  v_sub_u32 v194, v192, v194
  v_bfe_u32 v195, v193, 3, 1
  v_lshlrev_b32 v195, 1, v195
  v_xor_b32 v194, v194, v195
  v_mul_u32_u24 v193, 3072, v193
  v_lshl_add_u32 v1, v194, 4, v193
  v_mov_b32 v192, 163824
  v_mov_b64 v[194:195], 0
  v_mov_b64 v[196:197], 0
  ds_write_b128 v192, v[194:197]
  v_and_b32 v196, 15, v0
  v_lshrrev_b32 v197, 4, v0
  v_lshrrev_b32 v192, 1, v196
  v_xor_b32 v192, v192, v197
  v_lshlrev_b32 v192, 4, v192
  v_lshl_add_u32 v192, v196, 7, v192
  v_add_u32 v184, s59, v192
  v_xor_b32 v185, 64, v184
  v_add_u32 v186, 0x10000, v184
  v_add_u32 v187, 0x10000, v185
  v_bfe_u32 v192, v0, 2, 2
  v_lshl_add_u32 v192, v197, 3, v192
  v_mul_u32_u24 v192, 192, v192
  v_and_b32 v193, 3, v0
  v_lshl_add_u32 v192, v193, 3, v192
  v_add_u32 v192, 0x20000, v192
  v_and_b32 v193, 1, v197
  v_lshlrev_b32 v193, 5, v193
  v_add_u32 v246, v192, v193
  v_sub_u32 v247, v192, v193
  v_lshlrev_b32 v248, 9, v197
  v_lshl_add_u32 v248, v196, 4, v248
  s_lshl_b32 s52, s45, 2
  s_add_u32 s52, s52, s56
  s_mul_i32 s52, s52, 98304
  s_mul_i32 s53, s46, 6144
  s_add_u32 s52, s52, s53
  s_add_u32 s100, s52, 0x780000
  s_and_b32 s52, s2, 7
  s_lshr_b32 s53, s2, 6
  s_lshl2_add_u32 s48, s52, s53
  s_lshr_b32 s53, s2, 5
  s_lshl3_add_u32 s50, s52, s53
  s_and_b32 s51, s49, 3
  s_mul_i32 s52, s48, 1280
  s_mul_i32 s53, s48, 320
  s_add_u32 s52, s52, 0x280000
  s_add_u32 s53, s53, 0x500000
  v_add_u32 v192, 0, v0
  v_cmp_le_u32 vcc, 160, v192
  v_subrev_u32 v193, 160, v192
  v_mov_b32 v195, 0
  v_cndmask_b32 v192, v192, v193, vcc
  v_mov_b32 v196, 40960
  v_cndmask_b32 v195, v195, v196, vcc
  v_subrev_u32 v193, 80, v192
  v_mul_u32_u24 v194, 3277, v193
  v_lshrrev_b32 v194, 16, v194
  v_mul_u32_u24 v196, 9920, v194
  v_lshl_add_u32 v196, v193, 4, v196
  v_add_u32 v196, s53, v196
  v_cmp_gt_u32 vcc, 80, v192
  v_lshlrev_b32 v192, 4, v192
  v_add_u32 v192, s52, v192
  v_cndmask_b32 v192, v196, v192, vcc
  v_add_u32 v250, v192, v195
  v_add_u32 v192, 64, v0
  v_cmp_le_u32 vcc, 160, v192
  v_subrev_u32 v193, 160, v192
  v_mov_b32 v195, 0
  v_cndmask_b32 v192, v192, v193, vcc
  v_mov_b32 v196, 40960
  v_cndmask_b32 v195, v195, v196, vcc
  v_subrev_u32 v193, 80, v192
  v_mul_u32_u24 v194, 3277, v193
  v_lshrrev_b32 v194, 16, v194
  v_mul_u32_u24 v196, 9920, v194
  v_lshl_add_u32 v196, v193, 4, v196
  v_add_u32 v196, s53, v196
  v_cmp_gt_u32 vcc, 80, v192
  v_lshlrev_b32 v192, 4, v192
  v_add_u32 v192, s52, v192
  v_cndmask_b32 v192, v196, v192, vcc
  v_add_u32 v251, v192, v195
  v_add_u32 v192, 128, v0
  v_cmp_le_u32 vcc, 160, v192
  v_subrev_u32 v193, 160, v192
  v_mov_b32 v195, 0
  v_cndmask_b32 v192, v192, v193, vcc
  v_mov_b32 v196, 40960
  v_cndmask_b32 v195, v195, v196, vcc
  v_subrev_u32 v193, 80, v192
  v_mul_u32_u24 v194, 3277, v193
  v_lshrrev_b32 v194, 16, v194
  v_mul_u32_u24 v196, 9920, v194
  v_lshl_add_u32 v196, v193, 4, v196
  v_add_u32 v196, s53, v196
  v_cmp_gt_u32 vcc, 80, v192
  v_lshlrev_b32 v192, 4, v192
  v_add_u32 v192, s52, v192
  v_cndmask_b32 v192, v196, v192, vcc
  v_add_u32 v252, v192, v195
  v_add_u32 v192, 192, v0
  v_cmp_le_u32 vcc, 160, v192
  v_subrev_u32 v193, 160, v192
  v_mov_b32 v195, 0
  v_cndmask_b32 v192, v192, v193, vcc
  v_mov_b32 v196, 40960
  v_cndmask_b32 v195, v195, v196, vcc
  v_subrev_u32 v193, 80, v192
  v_mul_u32_u24 v194, 3277, v193
  v_lshrrev_b32 v194, 16, v194
  v_mul_u32_u24 v196, 9920, v194
  v_lshl_add_u32 v196, v193, 4, v196
  v_add_u32 v196, s53, v196
  v_cmp_gt_u32 vcc, 80, v192
  v_lshlrev_b32 v192, 4, v192
  v_add_u32 v192, s52, v192
  v_cndmask_b32 v192, v196, v192, vcc
  v_add_u32 v253, v192, v195
  v_add_u32 v192, 256, v0
  v_cmp_le_u32 vcc, 160, v192
  v_subrev_u32 v193, 160, v192
  v_mov_b32 v195, 0
  v_cndmask_b32 v192, v192, v193, vcc
  v_mov_b32 v196, 40960
  v_cndmask_b32 v195, v195, v196, vcc
  v_subrev_u32 v193, 80, v192
  v_mul_u32_u24 v194, 3277, v193
  v_lshrrev_b32 v194, 16, v194
  v_mul_u32_u24 v196, 9920, v194
  v_lshl_add_u32 v196, v193, 4, v196
  v_add_u32 v196, s53, v196
  v_cmp_gt_u32 vcc, 80, v192
  v_lshlrev_b32 v192, 4, v192
  v_add_u32 v192, s52, v192
  v_cndmask_b32 v192, v196, v192, vcc
  v_add_u32 v254, v192, v195
  s_waitcnt vmcnt(8) lgkmcnt(0)
  s_barrier
  s_add_u32 m0, s59, 65536
  s_nop 0
  buffer_load_dwordx4 v164, s[28:31], s57 offen offset:0 lds
  buffer_load_dwordx4 v165, s[28:31], s57 offen offset:1024 lds
  buffer_load_dwordx4 v166, s[28:31], s57 offen offset:2048 lds
  buffer_load_dwordx4 v167, s[28:31], s57 offen offset:3072 lds
  s_add_u32 m0, m0, 16384
  s_nop 0
  buffer_load_dwordx4 v168, s[32:35], s58 offen offset:0 lds
  buffer_load_dwordx4 v169, s[32:35], s58 offen offset:1024 lds
  buffer_load_dwordx4 v170, s[32:35], s58 offen offset:2048 lds
  buffer_load_dwordx4 v171, s[32:35], s58 offen offset:3072 lds
  s_add_u32 s11, s11, 2
  s_cmp_ge_u32 s11, 10
  s_cselect_b32 s53, 10, 0
  s_sub_u32 s11, s11, s53
  s_lshl_b32 s52, s11, 7
  s_add_u32 s57, s10, s52
  s_mul_i32 s52, s11, 245760
  s_add_u32 s58, s61, s52
  ds_read_b128 v[2:5], v184 offset:0
  ds_read_b128 v[6:9], v184 offset:2048
  ds_read_b128 v[10:13], v185 offset:0
  ds_read_b128 v[14:17], v185 offset:2048
  s_waitcnt vmcnt(8) lgkmcnt(0)
  s_barrier
  s_add_u32 m0, s59, 98304
  s_nop 0
  buffer_load_dwordx4 v164, s[28:31], s57 offen offset:0 lds
  buffer_load_dwordx4 v165, s[28:31], s57 offen offset:1024 lds
  buffer_load_dwordx4 v166, s[28:31], s57 offen offset:2048 lds
  buffer_load_dwordx4 v167, s[28:31], s57 offen offset:3072 lds
  s_add_u32 m0, m0, 16384
  s_nop 0
  buffer_load_dwordx4 v168, s[32:35], s58 offen offset:0 lds
  buffer_load_dwordx4 v169, s[32:35], s58 offen offset:1024 lds
  buffer_load_dwordx4 v170, s[32:35], s58 offen offset:2048 lds
  buffer_load_dwordx4 v171, s[32:35], s58 offen offset:3072 lds
  s_add_u32 s11, s11, 2
  s_cmp_ge_u32 s11, 10
  s_cselect_b32 s53, 10, 0
  s_sub_u32 s11, s11, s53
  s_lshl_b32 s52, s11, 7
  s_add_u32 s57, s10, s52
  s_mul_i32 s52, s11, 245760
  s_add_u32 s58, s61, s52
  ds_read_b128 v[18:21], v184 offset:32768
  ds_read_b128 v[22:25], v184 offset:34816
  ds_read_b128 v[26:29], v185 offset:32768
  ds_read_b128 v[30:33], v185 offset:34816
  s_waitcnt vmcnt(8) lgkmcnt(0)
  s_barrier
  s_add_u32 m0, s59, 0
  s_nop 0
  buffer_load_dwordx4 v164, s[28:31], s57 offen offset:0 lds
  buffer_load_dwordx4 v165, s[28:31], s57 offen offset:1024 lds
  buffer_load_dwordx4 v166, s[28:31], s57 offen offset:2048 lds
  buffer_load_dwordx4 v167, s[28:31], s57 offen offset:3072 lds
  s_add_u32 m0, m0, 16384
  s_nop 0
  buffer_load_dwordx4 v168, s[32:35], s58 offen offset:0 lds
  buffer_load_dwordx4 v169, s[32:35], s58 offen offset:1024 lds
  buffer_load_dwordx4 v170, s[32:35], s58 offen offset:2048 lds
  buffer_load_dwordx4 v171, s[32:35], s58 offen offset:3072 lds
  s_add_u32 s11, s11, 3
  s_cmp_ge_u32 s11, 10
  s_cselect_b32 s53, 10, 0
  s_sub_u32 s11, s11, s53
  s_lshl_b32 s52, s11, 7
  s_add_u32 s57, s10, s52
  s_mul_i32 s52, s11, 245760
  s_add_u32 s58, s61, s52
  ds_read_b128 v[34:37], v186 offset:0
  ds_read_b128 v[38:41], v186 offset:2048
  ds_read_b128 v[42:45], v187 offset:0
  ds_read_b128 v[46:49], v187 offset:2048
  s_waitcnt vmcnt(8) lgkmcnt(0)
  s_barrier
  s_add_u32 m0, s59, 32768
  s_nop 0
  buffer_load_dwordx4 v164, s[28:31], s57 offen offset:0 lds
  buffer_load_dwordx4 v165, s[28:31], s57 offen offset:1024 lds
  buffer_load_dwordx4 v166, s[28:31], s57 offen offset:2048 lds
  buffer_load_dwordx4 v167, s[28:31], s57 offen offset:3072 lds
  s_add_u32 m0, m0, 16384
  s_nop 0
  buffer_load_dwordx4 v168, s[32:35], s58 offen offset:0 lds
  buffer_load_dwordx4 v169, s[32:35], s58 offen offset:1024 lds
  buffer_load_dwordx4 v170, s[32:35], s58 offen offset:2048 lds
  buffer_load_dwordx4 v171, s[32:35], s58 offen offset:3072 lds
  s_add_u32 s11, s11, 2
  s_cmp_ge_u32 s11, 10
  s_cselect_b32 s53, 10, 0
  s_sub_u32 s11, s11, s53
  s_lshl_b32 s52, s11, 7
  s_add_u32 s57, s10, s52
  s_mul_i32 s52, s11, 245760
  s_add_u32 s58, s61, s52
  ds_read_b128 v[50:53], v186 offset:32768
  ds_read_b128 v[54:57], v186 offset:34816
  ds_read_b128 v[58:61], v187 offset:32768
  ds_read_b128 v[62:65], v187 offset:34816
  s_waitcnt vmcnt(8) lgkmcnt(0)
  s_barrier
  s_add_u32 m0, s59, 65536
  s_nop 0
  buffer_load_dwordx4 v164, s[28:31], s57 offen offset:0 lds
  buffer_load_dwordx4 v165, s[28:31], s57 offen offset:1024 lds
  buffer_load_dwordx4 v166, s[28:31], s57 offen offset:2048 lds
  buffer_load_dwordx4 v167, s[28:31], s57 offen offset:3072 lds
  s_add_u32 m0, m0, 16384
  s_nop 0
  buffer_load_dwordx4 v168, s[32:35], s58 offen offset:0 lds
  buffer_load_dwordx4 v169, s[32:35], s58 offen offset:1024 lds
  buffer_load_dwordx4 v170, s[32:35], s58 offen offset:2048 lds
  buffer_load_dwordx4 v171, s[32:35], s58 offen offset:3072 lds
  s_add_u32 s11, s11, 2
  s_cmp_ge_u32 s11, 10
  s_cselect_b32 s53, 10, 0
  s_sub_u32 s11, s11, s53
  s_lshl_b32 s52, s11, 7
  s_add_u32 s57, s10, s52
  s_mul_i32 s52, s11, 245760
  s_add_u32 s58, s61, s52
  ds_read_b128 v[66:69], v184 offset:0
  ds_read_b128 v[70:73], v184 offset:2048
  ds_read_b128 v[74:77], v185 offset:0
  ds_read_b128 v[78:81], v185 offset:2048
  s_waitcnt vmcnt(8) lgkmcnt(0)
  s_barrier
  s_add_u32 m0, s59, 98304
  s_nop 0
  buffer_load_dwordx4 v164, s[28:31], s57 offen offset:0 lds
  buffer_load_dwordx4 v165, s[28:31], s57 offen offset:1024 lds
  buffer_load_dwordx4 v166, s[28:31], s57 offen offset:2048 lds
  buffer_load_dwordx4 v167, s[28:31], s57 offen offset:3072 lds
  s_add_u32 m0, m0, 16384
  s_nop 0
  buffer_load_dwordx4 v168, s[32:35], s58 offen offset:0 lds
  buffer_load_dwordx4 v169, s[32:35], s58 offen offset:1024 lds
  buffer_load_dwordx4 v170, s[32:35], s58 offen offset:2048 lds
  buffer_load_dwordx4 v171, s[32:35], s58 offen offset:3072 lds
  s_add_u32 s11, s11, 2
  s_cmp_ge_u32 s11, 10
  s_cselect_b32 s53, 10, 0
  s_sub_u32 s11, s11, s53
  s_lshl_b32 s52, s11, 7
  s_add_u32 s57, s10, s52
  s_mul_i32 s52, s11, 245760
  s_add_u32 s58, s61, s52
  ds_read_b128 v[82:85], v184 offset:32768
  ds_read_b128 v[86:89], v184 offset:34816
  ds_read_b128 v[90:93], v185 offset:32768
  ds_read_b128 v[94:97], v185 offset:34816
  s_waitcnt vmcnt(8) lgkmcnt(0)
  s_barrier
  s_add_u32 m0, s59, 0
  s_nop 0
  buffer_load_dwordx4 v164, s[28:31], s57 offen offset:0 lds
  buffer_load_dwordx4 v165, s[28:31], s57 offen offset:1024 lds
  buffer_load_dwordx4 v166, s[28:31], s57 offen offset:2048 lds
  buffer_load_dwordx4 v167, s[28:31], s57 offen offset:3072 lds
  s_add_u32 m0, m0, 16384
  s_nop 0
  buffer_load_dwordx4 v168, s[32:35], s58 offen offset:0 lds
  buffer_load_dwordx4 v169, s[32:35], s58 offen offset:1024 lds
  buffer_load_dwordx4 v170, s[32:35], s58 offen offset:2048 lds
  buffer_load_dwordx4 v171, s[32:35], s58 offen offset:3072 lds
  s_add_u32 s11, s11, 2
  s_cmp_ge_u32 s11, 10
  s_cselect_b32 s53, 10, 0
  s_sub_u32 s11, s11, s53
  s_lshl_b32 s52, s11, 7
  s_add_u32 s57, s10, s52
  s_mul_i32 s52, s11, 245760
  s_add_u32 s58, s61, s52
  ds_read_b128 v[98:101], v186 offset:0
  ds_read_b128 v[102:105], v186 offset:2048
  ds_read_b128 v[106:109], v187 offset:0
  ds_read_b128 v[110:113], v187 offset:2048
  s_waitcnt vmcnt(8) lgkmcnt(0)
  s_barrier
  s_add_u32 m0, s59, 32768
  s_nop 0
  buffer_load_dwordx4 v164, s[28:31], s57 offen offset:0 lds
  buffer_load_dwordx4 v165, s[28:31], s57 offen offset:1024 lds
  buffer_load_dwordx4 v166, s[28:31], s57 offen offset:2048 lds
  buffer_load_dwordx4 v167, s[28:31], s57 offen offset:3072 lds
  s_add_u32 m0, m0, 16384
  s_nop 0
  buffer_load_dwordx4 v168, s[32:35], s58 offen offset:0 lds
  buffer_load_dwordx4 v169, s[32:35], s58 offen offset:1024 lds
  buffer_load_dwordx4 v170, s[32:35], s58 offen offset:2048 lds
  buffer_load_dwordx4 v171, s[32:35], s58 offen offset:3072 lds
  s_add_u32 s11, s11, 1
  s_cmp_ge_u32 s11, 10
  s_cselect_b32 s53, 10, 0
  s_sub_u32 s11, s11, s53
  s_lshl_b32 s52, s11, 7
  s_add_u32 s57, s10, s52
  s_mul_i32 s52, s11, 245760
  s_add_u32 s58, s61, s52
  s_mov_b32 s32, s12
  s_mov_b32 s33, s13
  s_mov_b32 s34, 0x1e0000
  s_mov_b32 s35, 0x20000
  s_mul_i32 s52, s56, 49152
  s_mul_i32 s53, s46, 192
  s_add_u32 s61, s52, s53
  s_mul_i32 s52, s11, 196608
  s_add_u32 s58, s61, s52
  s_mul_i32 s60, s56, 3072
  ds_read_b128 v[114:117], v186 offset:32768
  ds_read_b128 v[118:121], v186 offset:34816
  ds_read_b128 v[122:125], v187 offset:32768
  ds_read_b128 v[126:129], v187 offset:34816
  s_add_u32 m0, s60, 131072
  s_nop 0
  buffer_load_dwordx4 v249, s[32:35], s58 offen lds
  s_add_u32 m0, m0, 1024
  s_nop 0
  buffer_load_dwordx4 v255, s[32:35], s58 offen lds
  s_add_u32 m0, m0, 1024
  s_nop 0
  buffer_load_dwordx4 v1, s[32:35], s58 offen lds
  s_add_u32 s11, s11, 2
  s_cmp_ge_u32 s11, 10
  s_cselect_b32 s53, 10, 0
  s_sub_u32 s11, s11, s53
  s_mul_i32 s52, s11, 196608
  s_add_u32 s58, s61, s52
  s_add_u32 m0, s60, 143360
  s_nop 0
  buffer_load_dwordx4 v249, s[32:35], s58 offen lds
  s_add_u32 m0, m0, 1024
  s_nop 0
  buffer_load_dwordx4 v255, s[32:35], s58 offen lds
  s_add_u32 m0, m0, 1024
  s_nop 0
  buffer_load_dwordx4 v1, s[32:35], s58 offen lds
  s_add_u32 s11, s11, 2
  s_cmp_ge_u32 s11, 10
  s_cselect_b32 s53, 10, 0
  s_sub_u32 s11, s11, s53
  s_mul_i32 s52, s11, 196608
  s_add_u32 s58, s61, s52
  s_waitcnt vmcnt(14) lgkmcnt(0)
  s_barrier
  ds_read_b128 v[130:133], v184 offset:0
  ds_read_b128 v[134:137], v184 offset:2048
  ds_read_b128 v[138:141], v185 offset:0
  ds_read_b128 v[142:145], v185 offset:2048
  s_add_u32 m0, s60, 65536
  s_nop 0
  buffer_load_dwordx4 v249, s[32:35], s58 offen lds
  s_add_u32 m0, m0, 1024
  s_nop 0
  buffer_load_dwordx4 v255, s[32:35], s58 offen lds
  s_add_u32 m0, m0, 1024
  s_nop 0
  buffer_load_dwordx4 v1, s[32:35], s58 offen lds
  s_add_u32 s11, s11, 2
  s_cmp_ge_u32 s11, 10
  s_cselect_b32 s53, 10, 0
  s_sub_u32 s11, s11, s53
  s_mul_i32 s52, s11, 196608
  s_add_u32 s58, s61, s52
  s_waitcnt vmcnt(9) lgkmcnt(0)
  s_barrier
  ds_read_b128 v[146:149], v184 offset:32768
  ds_read_b128 v[150:153], v184 offset:34816
  ds_read_b128 v[154:157], v185 offset:32768
  ds_read_b128 v[158:161], v185 offset:34816
  s_add_u32 m0, s60, 77824
  s_nop 0
  buffer_load_dwordx4 v249, s[32:35], s58 offen lds
  s_add_u32 m0, m0, 1024
  s_nop 0
  buffer_load_dwordx4 v255, s[32:35], s58 offen lds
  s_add_u32 m0, m0, 1024
  s_nop 0
  buffer_load_dwordx4 v1, s[32:35], s58 offen lds
  s_add_u32 s11, s11, 2
  s_cmp_ge_u32 s11, 10
  s_cselect_b32 s53, 10, 0
  s_sub_u32 s11, s11, s53
  s_mul_i32 s52, s11, 196608
  s_add_u32 s58, s61, s52
  s_add_u32 m0, s60, 98304
  s_nop 0
  buffer_load_dwordx4 v249, s[32:35], s58 offen lds
  s_add_u32 m0, m0, 1024
  s_nop 0
  buffer_load_dwordx4 v255, s[32:35], s58 offen lds
  s_add_u32 m0, m0, 1024
  s_nop 0
  buffer_load_dwordx4 v1, s[32:35], s58 offen lds
  s_add_u32 s11, s11, 3
  s_cmp_ge_u32 s11, 10
  s_cselect_b32 s53, 10, 0
  s_sub_u32 s11, s11, s53
  s_mul_i32 s52, s11, 196608
  s_add_u32 s58, s61, s52
  s_waitcnt lgkmcnt(0)
  s_barrier
  s_add_u32 m0, s60, 110592
  s_nop 0
  buffer_load_dwordx4 v249, s[32:35], s58 offen lds
  s_add_u32 m0, m0, 1024
  s_nop 0
  buffer_load_dwordx4 v255, s[32:35], s58 offen lds
  s_add_u32 m0, m0, 1024
  s_nop 0
  buffer_load_dwordx4 v1, s[32:35], s58 offen lds
  s_add_u32 s11, s11, 2
  s_cmp_ge_u32 s11, 10
  s_cselect_b32 s53, 10, 0
  s_sub_u32 s11, s11, s53
  s_mul_i32 s52, s11, 196608
  s_add_u32 s58, s61, s52
  s_add_u32 m0, s60, 0
  s_nop 0
  buffer_load_dwordx4 v249, s[32:35], s58 offen lds
  s_add_u32 m0, m0, 1024
  s_nop 0
  buffer_load_dwordx4 v255, s[32:35], s58 offen lds
  s_add_u32 m0, m0, 1024
  s_nop 0
  buffer_load_dwordx4 v1, s[32:35], s58 offen lds
  s_add_u32 s11, s11, 2
  s_cmp_ge_u32 s11, 10
  s_cselect_b32 s53, 10, 0
  s_sub_u32 s11, s11, s53
  s_mul_i32 s52, s11, 196608
  s_add_u32 s58, s61, s52
  s_add_u32 m0, s60, 12288
  s_nop 0
  buffer_load_dwordx4 v249, s[32:35], s58 offen lds
  s_add_u32 m0, m0, 1024
  s_nop 0
  buffer_load_dwordx4 v255, s[32:35], s58 offen lds
  s_add_u32 m0, m0, 1024
  s_nop 0
  buffer_load_dwordx4 v1, s[32:35], s58 offen lds
  s_add_u32 s11, s11, 2
  s_cmp_ge_u32 s11, 10
  s_cselect_b32 s53, 10, 0
  s_sub_u32 s11, s11, s53
  s_mul_i32 s52, s11, 196608
  s_add_u32 s58, s61, s52
  s_add_u32 m0, s60, 32768
  s_nop 0
  buffer_load_dwordx4 v249, s[32:35], s58 offen lds
  s_add_u32 m0, m0, 1024
  s_nop 0
  buffer_load_dwordx4 v255, s[32:35], s58 offen lds
  s_add_u32 m0, m0, 1024
  s_nop 0
  buffer_load_dwordx4 v1, s[32:35], s58 offen lds
  s_add_u32 s11, s11, 2
  s_cmp_ge_u32 s11, 10
  s_cselect_b32 s53, 10, 0
  s_sub_u32 s11, s11, s53
  s_mul_i32 s52, s11, 196608
  s_add_u32 s58, s61, s52
  s_waitcnt vmcnt(21)
  s_barrier
  ds_read_b64_tr_b16 v[210:211], v246 offset:0
  ds_read_b64_tr_b16 v[212:213], v246 offset:768
  ds_read_b64_tr_b16 v[214:215], v247 offset:32
  ds_read_b64_tr_b16 v[216:217], v247 offset:800
  ds_read_b64_tr_b16 v[218:219], v246 offset:64
  ds_read_b64_tr_b16 v[220:221], v246 offset:832
  ds_read_b64_tr_b16 v[222:223], v247 offset:96
  ds_read_b64_tr_b16 v[224:225], v247 offset:864
  ds_read_b64_tr_b16 v[226:227], v246 offset:128
  ds_read_b64_tr_b16 v[228:229], v246 offset:896
  ds_read_b64_tr_b16 v[230:231], v247 offset:160
  ds_read_b64_tr_b16 v[232:233], v247 offset:928
  ds_read_b64_tr_b16 v[234:235], v246 offset:6144
  ds_read_b64_tr_b16 v[236:237], v246 offset:6912
  s_waitcnt lgkmcnt(10)
  v_mfma_f32_16x16x32_bf16 v[162:165], v[210:213], v[2:5], 0
  ds_read_b64_tr_b16 v[238:239], v247 offset:6176
  v_mfma_f32_16x16x32_bf16 v[166:169], v[210:213], v[6:9], 0
  ds_read_b64_tr_b16 v[240:241], v247 offset:6944
  v_mfma_f32_16x16x32_bf16 v[170:173], v[214:217], v[2:5], 0
  ds_read_b64_tr_b16 v[242:243], v246 offset:6208
  v_mfma_f32_16x16x32_bf16 v[174:177], v[214:217], v[6:9], 0
  ds_read_b64_tr_b16 v[244:245], v246 offset:6976
  s_waitcnt lgkmcnt(10)
  v_mfma_f32_16x16x32_bf16 v[178:181], v[218:221], v[2:5], 0
  ds_read_b64_tr_b16 v[210:211], v247 offset:6240
  v_mfma_f32_16x16x32_bf16 v[182:185], v[218:221], v[6:9], 0
  ds_read_b64_tr_b16 v[212:213], v247 offset:7008
  v_mfma_f32_16x16x32_bf16 v[186:189], v[222:225], v[2:5], 0
  ds_read_b64_tr_b16 v[214:215], v246 offset:6272
  v_mfma_f32_16x16x32_bf16 v[190:193], v[222:225], v[6:9], 0
  ds_read_b64_tr_b16 v[216:217], v246 offset:7040
  s_waitcnt lgkmcnt(10)
  v_mfma_f32_16x16x32_bf16 v[194:197], v[226:229], v[2:5], 0
  ds_read_b64_tr_b16 v[218:219], v247 offset:6304
  v_mfma_f32_16x16x32_bf16 v[198:201], v[226:229], v[6:9], 0
  ds_read_b64_tr_b16 v[220:221], v247 offset:7072
  v_mfma_f32_16x16x32_bf16 v[202:205], v[230:233], v[2:5], 0
  ds_read_b64_tr_b16 v[222:223], v246 offset:12288
  v_mfma_f32_16x16x32_bf16 v[206:209], v[230:233], v[6:9], 0
  ds_read_b64_tr_b16 v[224:225], v246 offset:13056
  v_mov_b32 v2, 163824
  v_mov_b32 v3, 1
  s_waitcnt lgkmcnt(10)
  v_mfma_f32_16x16x32_bf16 v[162:165], v[234:237], v[10:13], v[162:165]
  ds_read_b64_tr_b16 v[226:227], v247 offset:12320
  v_mfma_f32_16x16x32_bf16 v[166:169], v[234:237], v[14:17], v[166:169]
  ds_read_b64_tr_b16 v[228:229], v247 offset:13088
  v_mfma_f32_16x16x32_bf16 v[170:173], v[238:241], v[10:13], v[170:173]
  ds_read_b64_tr_b16 v[230:231], v246 offset:12352
  v_mfma_f32_16x16x32_bf16 v[174:177], v[238:241], v[14:17], v[174:177]
  ds_read_b64_tr_b16 v[232:233], v246 offset:13120
  s_waitcnt lgkmcnt(10)
  v_mfma_f32_16x16x32_bf16 v[178:181], v[242:245], v[10:13], v[178:181]
  ds_read_b64_tr_b16 v[234:235], v247 offset:12384
  v_mfma_f32_16x16x32_bf16 v[182:185], v[242:245], v[14:17], v[182:185]
  ds_read_b64_tr_b16 v[236:237], v247 offset:13152
  v_mfma_f32_16x16x32_bf16 v[186:189], v[210:213], v[10:13], v[186:189]
  ds_read_b64_tr_b16 v[238:239], v246 offset:12416
  v_mfma_f32_16x16x32_bf16 v[190:193], v[210:213], v[14:17], v[190:193]
  ds_read_b64_tr_b16 v[240:241], v246 offset:13184
  s_waitcnt lgkmcnt(10)
  v_mfma_f32_16x16x32_bf16 v[194:197], v[214:217], v[10:13], v[194:197]
  ds_read_b64_tr_b16 v[242:243], v247 offset:12448
  v_mfma_f32_16x16x32_bf16 v[198:201], v[214:217], v[14:17], v[198:201]
  ds_read_b64_tr_b16 v[244:245], v247 offset:13216
  s_waitcnt vmcnt(12)
  s_mov_b64 exec, 1
  ds_add_u32 v2, v3 offset:4
  s_mov_b64 exec, -1
  v_mfma_f32_16x16x32_bf16 v[202:205], v[218:221], v[10:13], v[202:205]
  ds_read_b64_tr_b16 v[210:211], v246 offset:18432
  v_mfma_f32_16x16x32_bf16 v[206:209], v[218:221], v[14:17], v[206:209]
  ds_read_b64_tr_b16 v[212:213], v246 offset:19200
  s_waitcnt lgkmcnt(11)
  v_mfma_f32_16x16x32_bf16 v[162:165], v[222:225], v[18:21], v[162:165]
  ds_read_b64_tr_b16 v[214:215], v247 offset:18464
  v_mfma_f32_16x16x32_bf16 v[166:169], v[222:225], v[22:25], v[166:169]
  ds_read_b64_tr_b16 v[216:217], v247 offset:19232
  v_mfma_f32_16x16x32_bf16 v[170:173], v[226:229], v[18:21], v[170:173]
  ds_read_b64_tr_b16 v[218:219], v246 offset:18496
  v_mfma_f32_16x16x32_bf16 v[174:177], v[226:229], v[22:25], v[174:177]
  ds_read_b64_tr_b16 v[220:221], v246 offset:19264
  ds_read_b32 v4, v2 offset:4
  s_waitcnt lgkmcnt(12)
  v_mfma_f32_16x16x32_bf16 v[178:181], v[230:233], v[18:21], v[178:181]
  ds_read_b64_tr_b16 v[222:223], v247 offset:18528
  v_mfma_f32_16x16x32_bf16 v[182:185], v[230:233], v[22:25], v[182:185]
  ds_read_b64_tr_b16 v[224:225], v247 offset:19296
  v_mfma_f32_16x16x32_bf16 v[186:189], v[234:237], v[18:21], v[186:189]
  ds_read_b64_tr_b16 v[226:227], v246 offset:18560
  v_mfma_f32_16x16x32_bf16 v[190:193], v[234:237], v[22:25], v[190:193]
  ds_read_b64_tr_b16 v[228:229], v246 offset:19328
  s_waitcnt lgkmcnt(12)
  v_mfma_f32_16x16x32_bf16 v[194:197], v[238:241], v[18:21], v[194:197]
  ds_read_b64_tr_b16 v[230:231], v247 offset:18592
  v_mfma_f32_16x16x32_bf16 v[198:201], v[238:241], v[22:25], v[198:201]
  ds_read_b64_tr_b16 v[232:233], v247 offset:19360
  s_waitcnt lgkmcnt(6)
  v_readfirstlane_b32 s52, v4
  s_cmp_lg_u32 s52, 4
  s_cbranch_scc1 L_wsp0
L_wsd0:
  v_subrev_u32 v246, 0x10000, v246
  v_subrev_u32 v247, 0x10000, v247
  v_mfma_f32_16x16x32_bf16 v[202:205], v[242:245], v[18:21], v[202:205]
  ds_read_b64_tr_b16 v[234:235], v246 offset:0
  v_mfma_f32_16x16x32_bf16 v[206:209], v[242:245], v[22:25], v[206:209]
  ds_read_b64_tr_b16 v[236:237], v246 offset:768
  s_waitcnt lgkmcnt(11)
  v_mfma_f32_16x16x32_bf16 v[162:165], v[210:213], v[26:29], v[162:165]
  ds_read_b64_tr_b16 v[238:239], v247 offset:32
  v_mfma_f32_16x16x32_bf16 v[166:169], v[210:213], v[30:33], v[166:169]
  ds_read_b64_tr_b16 v[240:241], v247 offset:800
  v_mfma_f32_16x16x32_bf16 v[170:173], v[214:217], v[26:29], v[170:173]
  ds_read_b64_tr_b16 v[242:243], v246 offset:64
  v_mfma_f32_16x16x32_bf16 v[174:177], v[214:217], v[30:33], v[174:177]
  ds_read_b64_tr_b16 v[244:245], v246 offset:832
  s_waitcnt lgkmcnt(10)
  v_mfma_f32_16x16x32_bf16 v[178:181], v[218:221], v[26:29], v[178:181]
  ds_read_b64_tr_b16 v[210:211], v247 offset:96
  v_mfma_f32_16x16x32_bf16 v[182:185], v[218:221], v[30:33], v[182:185]
  ds_read_b64_tr_b16 v[212:213], v247 offset:864
  v_mfma_f32_16x16x32_bf16 v[186:189], v[222:225], v[26:29], v[186:189]
  ds_read_b64_tr_b16 v[214:215], v246 offset:128
  v_mfma_f32_16x16x32_bf16 v[190:193], v[222:225], v[30:33], v[190:193]
  ds_read_b64_tr_b16 v[216:217], v246 offset:896
  s_waitcnt lgkmcnt(10)
  v_mfma_f32_16x16x32_bf16 v[194:197], v[226:229], v[26:29], v[194:197]
  ds_read_b64_tr_b16 v[218:219], v247 offset:160
  v_mfma_f32_16x16x32_bf16 v[198:201], v[226:229], v[30:33], v[198:201]
  ds_read_b64_tr_b16 v[220:221], v247 offset:928
  v_mfma_f32_16x16x32_bf16 v[202:205], v[230:233], v[26:29], v[202:205]
  ds_read_b64_tr_b16 v[222:223], v246 offset:6144
  v_mfma_f32_16x16x32_bf16 v[206:209], v[230:233], v[30:33], v[206:209]
  ds_read_b64_tr_b16 v[224:225], v246 offset:6912
  s_waitcnt lgkmcnt(10)
  v_mfma_f32_16x16x32_bf16 v[162:165], v[234:237], v[34:37], v[162:165]
  ds_read_b64_tr_b16 v[226:227], v247 offset:6176
  v_mfma_f32_16x16x32_bf16 v[166:169], v[234:237], v[38:41], v[166:169]
  ds_read_b64_tr_b16 v[228:229], v247 offset:6944
  v_mfma_f32_16x16x32_bf16 v[170:173], v[238:241], v[34:37], v[170:173]
  ds_read_b64_tr_b16 v[230:231], v246 offset:6208
  v_mfma_f32_16x16x32_bf16 v[174:177], v[238:241], v[38:41], v[174:177]
  ds_read_b64_tr_b16 v[232:233], v246 offset:6976
  s_waitcnt lgkmcnt(10)
  v_mfma_f32_16x16x32_bf16 v[178:181], v[242:245], v[34:37], v[178:181]
  ds_read_b64_tr_b16 v[234:235], v247 offset:6240
  v_mfma_f32_16x16x32_bf16 v[182:185], v[242:245], v[38:41], v[182:185]
  ds_read_b64_tr_b16 v[236:237], v247 offset:7008
  v_mfma_f32_16x16x32_bf16 v[186:189], v[210:213], v[34:37], v[186:189]
  ds_read_b64_tr_b16 v[238:239], v246 offset:6272
  v_mfma_f32_16x16x32_bf16 v[190:193], v[210:213], v[38:41], v[190:193]
  ds_read_b64_tr_b16 v[240:241], v246 offset:7040
  s_waitcnt lgkmcnt(10)
  v_mfma_f32_16x16x32_bf16 v[194:197], v[214:217], v[34:37], v[194:197]
  ds_read_b64_tr_b16 v[242:243], v247 offset:6304
  v_mfma_f32_16x16x32_bf16 v[198:201], v[214:217], v[38:41], v[198:201]
  ds_read_b64_tr_b16 v[244:245], v247 offset:7072
  v_mfma_f32_16x16x32_bf16 v[202:205], v[218:221], v[34:37], v[202:205]
  ds_read_b64_tr_b16 v[210:211], v246 offset:12288
  v_mfma_f32_16x16x32_bf16 v[206:209], v[218:221], v[38:41], v[206:209]
  ds_read_b64_tr_b16 v[212:213], v246 offset:13056
  s_waitcnt lgkmcnt(10)
  v_mfma_f32_16x16x32_bf16 v[162:165], v[222:225], v[42:45], v[162:165]
  ds_read_b64_tr_b16 v[214:215], v247 offset:12320
  v_mfma_f32_16x16x32_bf16 v[166:169], v[222:225], v[46:49], v[166:169]
  ds_read_b64_tr_b16 v[216:217], v247 offset:13088
  v_mfma_f32_16x16x32_bf16 v[170:173], v[226:229], v[42:45], v[170:173]
  ds_read_b64_tr_b16 v[218:219], v246 offset:12352
  v_mfma_f32_16x16x32_bf16 v[174:177], v[226:229], v[46:49], v[174:177]
  ds_read_b64_tr_b16 v[220:221], v246 offset:13120
  s_waitcnt lgkmcnt(10)
  v_mfma_f32_16x16x32_bf16 v[178:181], v[230:233], v[42:45], v[178:181]
  ds_read_b64_tr_b16 v[222:223], v247 offset:12384
  v_mfma_f32_16x16x32_bf16 v[182:185], v[230:233], v[46:49], v[182:185]
  ds_read_b64_tr_b16 v[224:225], v247 offset:13152
  v_mfma_f32_16x16x32_bf16 v[186:189], v[234:237], v[42:45], v[186:189]
  ds_read_b64_tr_b16 v[226:227], v246 offset:12416
  v_mfma_f32_16x16x32_bf16 v[190:193], v[234:237], v[46:49], v[190:193]
  ds_read_b64_tr_b16 v[228:229], v246 offset:13184
  s_waitcnt lgkmcnt(10)
  v_mfma_f32_16x16x32_bf16 v[194:197], v[238:241], v[42:45], v[194:197]
  ds_read_b64_tr_b16 v[230:231], v247 offset:12448
  v_mfma_f32_16x16x32_bf16 v[198:201], v[238:241], v[46:49], v[198:201]
  ds_read_b64_tr_b16 v[232:233], v247 offset:13216
  v_mfma_f32_16x16x32_bf16 v[202:205], v[242:245], v[42:45], v[202:205]
  ds_read_b64_tr_b16 v[234:235], v246 offset:18432
  v_mfma_f32_16x16x32_bf16 v[206:209], v[242:245], v[46:49], v[206:209]
  ds_read_b64_tr_b16 v[236:237], v246 offset:19200
  s_waitcnt lgkmcnt(10)
  v_mfma_f32_16x16x32_bf16 v[162:165], v[210:213], v[50:53], v[162:165]
  ds_read_b64_tr_b16 v[238:239], v247 offset:18464
  v_mfma_f32_16x16x32_bf16 v[166:169], v[210:213], v[54:57], v[166:169]
  ds_read_b64_tr_b16 v[240:241], v247 offset:19232
  v_mfma_f32_16x16x32_bf16 v[170:173], v[214:217], v[50:53], v[170:173]
  ds_read_b64_tr_b16 v[242:243], v246 offset:18496
  v_mfma_f32_16x16x32_bf16 v[174:177], v[214:217], v[54:57], v[174:177]
  ds_read_b64_tr_b16 v[244:245], v246 offset:19264
  s_waitcnt lgkmcnt(10)
  v_mfma_f32_16x16x32_bf16 v[178:181], v[218:221], v[50:53], v[178:181]
  ds_read_b64_tr_b16 v[210:211], v247 offset:18528
  v_mfma_f32_16x16x32_bf16 v[182:185], v[218:221], v[54:57], v[182:185]
  ds_read_b64_tr_b16 v[212:213], v247 offset:19296
  v_mfma_f32_16x16x32_bf16 v[186:189], v[222:225], v[50:53], v[186:189]
  ds_read_b64_tr_b16 v[214:215], v246 offset:18560
  v_mfma_f32_16x16x32_bf16 v[190:193], v[222:225], v[54:57], v[190:193]
  ds_read_b64_tr_b16 v[216:217], v246 offset:19328
  s_waitcnt lgkmcnt(10)
  v_mfma_f32_16x16x32_bf16 v[194:197], v[226:229], v[50:53], v[194:197]
  ds_read_b64_tr_b16 v[218:219], v247 offset:18592
  v_mfma_f32_16x16x32_bf16 v[198:201], v[226:229], v[54:57], v[198:201]
  ds_read_b64_tr_b16 v[220:221], v247 offset:19360
  v_mfma_f32_16x16x32_bf16 v[202:205], v[230:233], v[50:53], v[202:205]
  ds_read_b64_tr_b16 v[222:223], v246 offset:32768
  v_mfma_f32_16x16x32_bf16 v[206:209], v[230:233], v[54:57], v[206:209]
  ds_read_b64_tr_b16 v[224:225], v246 offset:33536
  s_waitcnt lgkmcnt(10)
  v_mfma_f32_16x16x32_bf16 v[162:165], v[234:237], v[58:61], v[162:165]
  ds_read_b64_tr_b16 v[226:227], v247 offset:32800
  v_mfma_f32_16x16x32_bf16 v[166:169], v[234:237], v[62:65], v[166:169]
  ds_read_b64_tr_b16 v[228:229], v247 offset:33568
  v_mfma_f32_16x16x32_bf16 v[170:173], v[238:241], v[58:61], v[170:173]
  ds_read_b64_tr_b16 v[230:231], v246 offset:32832
  v_mfma_f32_16x16x32_bf16 v[174:177], v[238:241], v[62:65], v[174:177]
  ds_read_b64_tr_b16 v[232:233], v246 offset:33600
  s_waitcnt lgkmcnt(10)
  v_mfma_f32_16x16x32_bf16 v[178:181], v[242:245], v[58:61], v[178:181]
  ds_read_b64_tr_b16 v[234:235], v247 offset:32864
  v_mfma_f32_16x16x32_bf16 v[182:185], v[242:245], v[62:65], v[182:185]
  ds_read_b64_tr_b16 v[236:237], v247 offset:33632
  v_mfma_f32_16x16x32_bf16 v[186:189], v[210:213], v[58:61], v[186:189]
  ds_read_b64_tr_b16 v[238:239], v246 offset:32896
  v_mfma_f32_16x16x32_bf16 v[190:193], v[210:213], v[62:65], v[190:193]
  ds_read_b64_tr_b16 v[240:241], v246 offset:33664
  s_waitcnt lgkmcnt(10)
  v_mfma_f32_16x16x32_bf16 v[194:197], v[214:217], v[58:61], v[194:197]
  ds_read_b64_tr_b16 v[242:243], v247 offset:32928
  v_mfma_f32_16x16x32_bf16 v[198:201], v[214:217], v[62:65], v[198:201]
  ds_read_b64_tr_b16 v[244:245], v247 offset:33696
  s_waitcnt vmcnt(0)
  s_mov_b64 exec, 1
  ds_add_u32 v2, v3 offset:8
  s_mov_b64 exec, -1
  v_mfma_f32_16x16x32_bf16 v[202:205], v[218:221], v[58:61], v[202:205]
  ds_read_b64_tr_b16 v[210:211], v246 offset:38912
  v_mfma_f32_16x16x32_bf16 v[206:209], v[218:221], v[62:65], v[206:209]
  ds_read_b64_tr_b16 v[212:213], v246 offset:39680
  s_waitcnt lgkmcnt(11)
  v_mfma_f32_16x16x32_bf16 v[162:165], v[222:225], v[66:69], v[162:165]
  ds_read_b64_tr_b16 v[214:215], v247 offset:38944
  v_mfma_f32_16x16x32_bf16 v[166:169], v[222:225], v[70:73], v[166:169]
  ds_read_b64_tr_b16 v[216:217], v247 offset:39712
  v_mfma_f32_16x16x32_bf16 v[170:173], v[226:229], v[66:69], v[170:173]
  ds_read_b64_tr_b16 v[218:219], v246 offset:38976
  v_mfma_f32_16x16x32_bf16 v[174:177], v[226:229], v[70:73], v[174:177]
  ds_read_b64_tr_b16 v[220:221], v246 offset:39744
  ds_read_b32 v4, v2 offset:8
  s_waitcnt lgkmcnt(12)
  v_mfma_f32_16x16x32_bf16 v[178:181], v[230:233], v[66:69], v[178:181]
  ds_read_b64_tr_b16 v[222:223], v247 offset:39008
  v_mfma_f32_16x16x32_bf16 v[182:185], v[230:233], v[70:73], v[182:185]
  ds_read_b64_tr_b16 v[224:225], v247 offset:39776
  v_mfma_f32_16x16x32_bf16 v[186:189], v[234:237], v[66:69], v[186:189]
  ds_read_b64_tr_b16 v[226:227], v246 offset:39040
  v_mfma_f32_16x16x32_bf16 v[190:193], v[234:237], v[70:73], v[190:193]
  ds_read_b64_tr_b16 v[228:229], v246 offset:39808
  s_waitcnt lgkmcnt(12)
  v_mfma_f32_16x16x32_bf16 v[194:197], v[238:241], v[66:69], v[194:197]
  ds_read_b64_tr_b16 v[230:231], v247 offset:39072
  v_mfma_f32_16x16x32_bf16 v[198:201], v[238:241], v[70:73], v[198:201]
  ds_read_b64_tr_b16 v[232:233], v247 offset:39840
  s_waitcnt lgkmcnt(6)
  v_readfirstlane_b32 s52, v4
  s_cmp_lg_u32 s52, 4
  s_cbranch_scc1 L_wsp1
L_wsd1:
  v_mfma_f32_16x16x32_bf16 v[202:205], v[242:245], v[66:69], v[202:205]
  ds_read_b64_tr_b16 v[234:235], v246 offset:45056
  v_mfma_f32_16x16x32_bf16 v[206:209], v[242:245], v[70:73], v[206:209]
  ds_read_b64_tr_b16 v[236:237], v246 offset:45824
  s_waitcnt lgkmcnt(11)
  v_mfma_f32_16x16x32_bf16 v[162:165], v[210:213], v[74:77], v[162:165]
  ds_read_b64_tr_b16 v[238:239], v247 offset:45088
  v_mfma_f32_16x16x32_bf16 v[166:169], v[210:213], v[78:81], v[166:169]
  ds_read_b64_tr_b16 v[240:241], v247 offset:45856
  v_mfma_f32_16x16x32_bf16 v[170:173], v[214:217], v[74:77], v[170:173]
  ds_read_b64_tr_b16 v[242:243], v246 offset:45120
  v_mfma_f32_16x16x32_bf16 v[174:177], v[214:217], v[78:81], v[174:177]
  ds_read_b64_tr_b16 v[244:245], v246 offset:45888
  s_waitcnt lgkmcnt(10)
  v_mfma_f32_16x16x32_bf16 v[178:181], v[218:221], v[74:77], v[178:181]
  ds_read_b64_tr_b16 v[210:211], v247 offset:45152
  v_mfma_f32_16x16x32_bf16 v[182:185], v[218:221], v[78:81], v[182:185]
  ds_read_b64_tr_b16 v[212:213], v247 offset:45920
  v_mfma_f32_16x16x32_bf16 v[186:189], v[222:225], v[74:77], v[186:189]
  ds_read_b64_tr_b16 v[214:215], v246 offset:45184
  v_mfma_f32_16x16x32_bf16 v[190:193], v[222:225], v[78:81], v[190:193]
  ds_read_b64_tr_b16 v[216:217], v246 offset:45952
  s_waitcnt lgkmcnt(10)
  v_mfma_f32_16x16x32_bf16 v[194:197], v[226:229], v[74:77], v[194:197]
  ds_read_b64_tr_b16 v[218:219], v247 offset:45216
  v_mfma_f32_16x16x32_bf16 v[198:201], v[226:229], v[78:81], v[198:201]
  ds_read_b64_tr_b16 v[220:221], v247 offset:45984
  v_mfma_f32_16x16x32_bf16 v[202:205], v[230:233], v[74:77], v[202:205]
  ds_read_b64_tr_b16 v[222:223], v246 offset:51200
  v_mfma_f32_16x16x32_bf16 v[206:209], v[230:233], v[78:81], v[206:209]
  ds_read_b64_tr_b16 v[224:225], v246 offset:51968
  s_waitcnt lgkmcnt(10)
  v_mfma_f32_16x16x32_bf16 v[162:165], v[234:237], v[82:85], v[162:165]
  ds_read_b64_tr_b16 v[226:227], v247 offset:51232
  v_mfma_f32_16x16x32_bf16 v[166:169], v[234:237], v[86:89], v[166:169]
  ds_read_b64_tr_b16 v[228:229], v247 offset:52000
  v_mfma_f32_16x16x32_bf16 v[170:173], v[238:241], v[82:85], v[170:173]
  ds_read_b64_tr_b16 v[230:231], v246 offset:51264
  v_mfma_f32_16x16x32_bf16 v[174:177], v[238:241], v[86:89], v[174:177]
  ds_read_b64_tr_b16 v[232:233], v246 offset:52032
  s_waitcnt lgkmcnt(10)
  v_mfma_f32_16x16x32_bf16 v[178:181], v[242:245], v[82:85], v[178:181]
  ds_read_b64_tr_b16 v[234:235], v247 offset:51296
  v_mfma_f32_16x16x32_bf16 v[182:185], v[242:245], v[86:89], v[182:185]
  ds_read_b64_tr_b16 v[236:237], v247 offset:52064
  v_mfma_f32_16x16x32_bf16 v[186:189], v[210:213], v[82:85], v[186:189]
  ds_read_b64_tr_b16 v[238:239], v246 offset:51328
  v_mfma_f32_16x16x32_bf16 v[190:193], v[210:213], v[86:89], v[190:193]
  ds_read_b64_tr_b16 v[240:241], v246 offset:52096
  s_waitcnt lgkmcnt(10)
  v_mfma_f32_16x16x32_bf16 v[194:197], v[214:217], v[82:85], v[194:197]
  ds_read_b64_tr_b16 v[242:243], v247 offset:51360
  v_mfma_f32_16x16x32_bf16 v[198:201], v[214:217], v[86:89], v[198:201]
  ds_read_b64_tr_b16 v[244:245], v247 offset:52128
  v_subrev_u32 v246, 0x10000, v246
  v_subrev_u32 v247, 0x10000, v247
  v_mfma_f32_16x16x32_bf16 v[202:205], v[218:221], v[82:85], v[202:205]
  ds_read_b64_tr_b16 v[210:211], v246 offset:0
  v_mfma_f32_16x16x32_bf16 v[206:209], v[218:221], v[86:89], v[206:209]
  ds_read_b64_tr_b16 v[212:213], v246 offset:768
  s_waitcnt lgkmcnt(10)
  v_mfma_f32_16x16x32_bf16 v[162:165], v[222:225], v[90:93], v[162:165]
  ds_read_b64_tr_b16 v[214:215], v247 offset:32
  v_mfma_f32_16x16x32_bf16 v[166:169], v[222:225], v[94:97], v[166:169]
  ds_read_b64_tr_b16 v[216:217], v247 offset:800
  v_mfma_f32_16x16x32_bf16 v[170:173], v[226:229], v[90:93], v[170:173]
  ds_read_b64_tr_b16 v[218:219], v246 offset:64
  v_mfma_f32_16x16x32_bf16 v[174:177], v[226:229], v[94:97], v[174:177]
  ds_read_b64_tr_b16 v[220:221], v246 offset:832
  s_waitcnt lgkmcnt(10)
  v_mfma_f32_16x16x32_bf16 v[178:181], v[230:233], v[90:93], v[178:181]
  ds_read_b64_tr_b16 v[222:223], v247 offset:96
  v_mfma_f32_16x16x32_bf16 v[182:185], v[230:233], v[94:97], v[182:185]
  ds_read_b64_tr_b16 v[224:225], v247 offset:864
  v_mfma_f32_16x16x32_bf16 v[186:189], v[234:237], v[90:93], v[186:189]
  ds_read_b64_tr_b16 v[226:227], v246 offset:128
  v_mfma_f32_16x16x32_bf16 v[190:193], v[234:237], v[94:97], v[190:193]
  ds_read_b64_tr_b16 v[228:229], v246 offset:896
  s_waitcnt lgkmcnt(10)
  v_mfma_f32_16x16x32_bf16 v[194:197], v[238:241], v[90:93], v[194:197]
  ds_read_b64_tr_b16 v[230:231], v247 offset:160
  v_mfma_f32_16x16x32_bf16 v[198:201], v[238:241], v[94:97], v[198:201]
  ds_read_b64_tr_b16 v[232:233], v247 offset:928
  v_mfma_f32_16x16x32_bf16 v[202:205], v[242:245], v[90:93], v[202:205]
  ds_read_b64_tr_b16 v[234:235], v246 offset:6144
  v_mfma_f32_16x16x32_bf16 v[206:209], v[242:245], v[94:97], v[206:209]
  ds_read_b64_tr_b16 v[236:237], v246 offset:6912
  s_waitcnt lgkmcnt(10)
  v_mfma_f32_16x16x32_bf16 v[162:165], v[210:213], v[98:101], v[162:165]
  ds_read_b64_tr_b16 v[238:239], v247 offset:6176
  v_mfma_f32_16x16x32_bf16 v[166:169], v[210:213], v[102:105], v[166:169]
  ds_read_b64_tr_b16 v[240:241], v247 offset:6944
  v_mfma_f32_16x16x32_bf16 v[170:173], v[214:217], v[98:101], v[170:173]
  ds_read_b64_tr_b16 v[242:243], v246 offset:6208
  v_mfma_f32_16x16x32_bf16 v[174:177], v[214:217], v[102:105], v[174:177]
  ds_read_b64_tr_b16 v[244:245], v246 offset:6976
  s_waitcnt lgkmcnt(10)
  v_mfma_f32_16x16x32_bf16 v[178:181], v[218:221], v[98:101], v[178:181]
  ds_read_b64_tr_b16 v[210:211], v247 offset:6240
  v_mfma_f32_16x16x32_bf16 v[182:185], v[218:221], v[102:105], v[182:185]
  ds_read_b64_tr_b16 v[212:213], v247 offset:7008
  v_mfma_f32_16x16x32_bf16 v[186:189], v[222:225], v[98:101], v[186:189]
  ds_read_b64_tr_b16 v[214:215], v246 offset:6272
  v_mfma_f32_16x16x32_bf16 v[190:193], v[222:225], v[102:105], v[190:193]
  ds_read_b64_tr_b16 v[216:217], v246 offset:7040
  s_waitcnt lgkmcnt(10)
  v_mfma_f32_16x16x32_bf16 v[194:197], v[226:229], v[98:101], v[194:197]
  ds_read_b64_tr_b16 v[218:219], v247 offset:6304
  v_mfma_f32_16x16x32_bf16 v[198:201], v[226:229], v[102:105], v[198:201]
  ds_read_b64_tr_b16 v[220:221], v247 offset:7072
  v_mfma_f32_16x16x32_bf16 v[202:205], v[230:233], v[98:101], v[202:205]
  ds_read_b64_tr_b16 v[222:223], v246 offset:12288
  v_mfma_f32_16x16x32_bf16 v[206:209], v[230:233], v[102:105], v[206:209]
  ds_read_b64_tr_b16 v[224:225], v246 offset:13056
  s_waitcnt lgkmcnt(10)
  v_mfma_f32_16x16x32_bf16 v[162:165], v[234:237], v[106:109], v[162:165]
  ds_read_b64_tr_b16 v[226:227], v247 offset:12320
  v_mfma_f32_16x16x32_bf16 v[166:169], v[234:237], v[110:113], v[166:169]
  ds_read_b64_tr_b16 v[228:229], v247 offset:13088
  v_mfma_f32_16x16x32_bf16 v[170:173], v[238:241], v[106:109], v[170:173]
  ds_read_b64_tr_b16 v[230:231], v246 offset:12352
  v_mfma_f32_16x16x32_bf16 v[174:177], v[238:241], v[110:113], v[174:177]
  ds_read_b64_tr_b16 v[232:233], v246 offset:13120
  s_waitcnt lgkmcnt(10)
  v_mfma_f32_16x16x32_bf16 v[178:181], v[242:245], v[106:109], v[178:181]
  ds_read_b64_tr_b16 v[234:235], v247 offset:12384
  v_mfma_f32_16x16x32_bf16 v[182:185], v[242:245], v[110:113], v[182:185]
  ds_read_b64_tr_b16 v[236:237], v247 offset:13152
  v_mfma_f32_16x16x32_bf16 v[186:189], v[210:213], v[106:109], v[186:189]
  ds_read_b64_tr_b16 v[238:239], v246 offset:12416
  v_mfma_f32_16x16x32_bf16 v[190:193], v[210:213], v[110:113], v[190:193]
  ds_read_b64_tr_b16 v[240:241], v246 offset:13184
L_sgsp:
  ds_read_b32 v4, v2
  s_waitcnt lgkmcnt(0)
  v_readfirstlane_b32 s52, v4
  s_cmp_lg_u32 s52, 5
  s_cbranch_scc1 L_sgsp
  s_add_u32 m0, s60, 45056
  s_nop 0
  buffer_load_dwordx4 v249, s[32:35], s58 offen lds
  s_add_u32 m0, m0, 1024
  s_nop 0
  buffer_load_dwordx4 v255, s[32:35], s58 offen lds
  s_add_u32 m0, m0, 1024
  s_nop 0
  buffer_load_dwordx4 v1, s[32:35], s58 offen lds
  s_waitcnt lgkmcnt(10)
  v_mfma_f32_16x16x32_bf16 v[194:197], v[214:217], v[106:109], v[194:197]
  ds_read_b64_tr_b16 v[242:243], v247 offset:12448
  v_mfma_f32_16x16x32_bf16 v[198:201], v[214:217], v[110:113], v[198:201]
  ds_read_b64_tr_b16 v[244:245], v247 offset:13216
  v_mfma_f32_16x16x32_bf16 v[202:205], v[218:221], v[106:109], v[202:205]
  ds_read_b64_tr_b16 v[210:211], v246 offset:18432
  v_mfma_f32_16x16x32_bf16 v[206:209], v[218:221], v[110:113], v[206:209]
  ds_read_b64_tr_b16 v[212:213], v246 offset:19200
  s_waitcnt lgkmcnt(10)
  v_mfma_f32_16x16x32_bf16 v[162:165], v[222:225], v[114:117], v[162:165]
  ds_read_b64_tr_b16 v[214:215], v247 offset:18464
  v_mfma_f32_16x16x32_bf16 v[166:169], v[222:225], v[118:121], v[166:169]
  ds_read_b64_tr_b16 v[216:217], v247 offset:19232
  v_mfma_f32_16x16x32_bf16 v[170:173], v[226:229], v[114:117], v[170:173]
  ds_read_b64_tr_b16 v[218:219], v246 offset:18496
  v_mfma_f32_16x16x32_bf16 v[174:177], v[226:229], v[118:121], v[174:177]
  ds_read_b64_tr_b16 v[220:221], v246 offset:19264
  s_waitcnt lgkmcnt(10)
  v_mfma_f32_16x16x32_bf16 v[178:181], v[230:233], v[114:117], v[178:181]
  ds_read_b64_tr_b16 v[222:223], v247 offset:18528
  v_mfma_f32_16x16x32_bf16 v[182:185], v[230:233], v[118:121], v[182:185]
  ds_read_b64_tr_b16 v[224:225], v247 offset:19296
  v_mfma_f32_16x16x32_bf16 v[186:189], v[234:237], v[114:117], v[186:189]
  ds_read_b64_tr_b16 v[226:227], v246 offset:18560
  v_mfma_f32_16x16x32_bf16 v[190:193], v[234:237], v[118:121], v[190:193]
  ds_read_b64_tr_b16 v[228:229], v246 offset:19328
  s_waitcnt lgkmcnt(10)
  v_mfma_f32_16x16x32_bf16 v[194:197], v[238:241], v[114:117], v[194:197]
  ds_read_b64_tr_b16 v[230:231], v247 offset:18592
  v_mfma_f32_16x16x32_bf16 v[198:201], v[238:241], v[118:121], v[198:201]
  ds_read_b64_tr_b16 v[232:233], v247 offset:19360
  v_mfma_f32_16x16x32_bf16 v[202:205], v[242:245], v[114:117], v[202:205]
  ds_read_b64_tr_b16 v[234:235], v246 offset:32768
  v_mfma_f32_16x16x32_bf16 v[206:209], v[242:245], v[118:121], v[206:209]
  ds_read_b64_tr_b16 v[236:237], v246 offset:33536
  s_waitcnt lgkmcnt(10)
  v_mfma_f32_16x16x32_bf16 v[162:165], v[210:213], v[122:125], v[162:165]
  ds_read_b64_tr_b16 v[238:239], v247 offset:32800
  v_mfma_f32_16x16x32_bf16 v[166:169], v[210:213], v[126:129], v[166:169]
  ds_read_b64_tr_b16 v[240:241], v247 offset:33568
  v_mfma_f32_16x16x32_bf16 v[170:173], v[214:217], v[122:125], v[170:173]
  ds_read_b64_tr_b16 v[242:243], v246 offset:32832
  v_mfma_f32_16x16x32_bf16 v[174:177], v[214:217], v[126:129], v[174:177]
  ds_read_b64_tr_b16 v[244:245], v246 offset:33600
  s_waitcnt lgkmcnt(10)
  v_mfma_f32_16x16x32_bf16 v[178:181], v[218:221], v[122:125], v[178:181]
  ds_read_b64_tr_b16 v[210:211], v247 offset:32864
  v_mfma_f32_16x16x32_bf16 v[182:185], v[218:221], v[126:129], v[182:185]
  ds_read_b64_tr_b16 v[212:213], v247 offset:33632
  v_mfma_f32_16x16x32_bf16 v[186:189], v[222:225], v[122:125], v[186:189]
  ds_read_b64_tr_b16 v[214:215], v246 offset:32896
  v_mfma_f32_16x16x32_bf16 v[190:193], v[222:225], v[126:129], v[190:193]
  ds_read_b64_tr_b16 v[216:217], v246 offset:33664
  s_waitcnt lgkmcnt(10)
  v_mfma_f32_16x16x32_bf16 v[194:197], v[226:229], v[122:125], v[194:197]
  ds_read_b64_tr_b16 v[218:219], v247 offset:32928
  v_mfma_f32_16x16x32_bf16 v[198:201], v[226:229], v[126:129], v[198:201]
  ds_read_b64_tr_b16 v[220:221], v247 offset:33696
  s_waitcnt vmcnt(0)
  s_mov_b64 exec, 1
  ds_add_u32 v2, v3 offset:12
  s_mov_b64 exec, -1
  v_mfma_f32_16x16x32_bf16 v[202:205], v[230:233], v[122:125], v[202:205]
  ds_read_b64_tr_b16 v[222:223], v246 offset:38912
  v_mfma_f32_16x16x32_bf16 v[206:209], v[230:233], v[126:129], v[206:209]
  ds_read_b64_tr_b16 v[224:225], v246 offset:39680
  s_waitcnt lgkmcnt(11)
  v_mfma_f32_16x16x32_bf16 v[162:165], v[234:237], v[130:133], v[162:165]
  ds_read_b64_tr_b16 v[226:227], v247 offset:38944
  v_mfma_f32_16x16x32_bf16 v[166:169], v[234:237], v[134:137], v[166:169]
  ds_read_b64_tr_b16 v[228:229], v247 offset:39712
  v_mfma_f32_16x16x32_bf16 v[170:173], v[238:241], v[130:133], v[170:173]
  ds_read_b64_tr_b16 v[230:231], v246 offset:38976
  v_mfma_f32_16x16x32_bf16 v[174:177], v[238:241], v[134:137], v[174:177]
  ds_read_b64_tr_b16 v[232:233], v246 offset:39744
  ds_read_b32 v4, v2 offset:12
  s_waitcnt lgkmcnt(12)
  v_mfma_f32_16x16x32_bf16 v[178:181], v[242:245], v[130:133], v[178:181]
  ds_read_b64_tr_b16 v[234:235], v247 offset:39008
  v_mfma_f32_16x16x32_bf16 v[182:185], v[242:245], v[134:137], v[182:185]
  ds_read_b64_tr_b16 v[236:237], v247 offset:39776
  v_mfma_f32_16x16x32_bf16 v[186:189], v[210:213], v[130:133], v[186:189]
  ds_read_b64_tr_b16 v[238:239], v246 offset:39040
  v_mfma_f32_16x16x32_bf16 v[190:193], v[210:213], v[134:137], v[190:193]
  ds_read_b64_tr_b16 v[240:241], v246 offset:39808
  s_waitcnt lgkmcnt(12)
  v_mfma_f32_16x16x32_bf16 v[194:197], v[214:217], v[130:133], v[194:197]
  ds_read_b64_tr_b16 v[242:243], v247 offset:39072
  v_mfma_f32_16x16x32_bf16 v[198:201], v[214:217], v[134:137], v[198:201]
  ds_read_b64_tr_b16 v[244:245], v247 offset:39840
  s_waitcnt lgkmcnt(6)
  v_readfirstlane_b32 s52, v4
  s_cmp_lg_u32 s52, 4
  s_cbranch_scc1 L_wsp2
L_wsd2:
  v_mfma_f32_16x16x32_bf16 v[202:205], v[218:221], v[130:133], v[202:205]
  ds_read_b64_tr_b16 v[210:211], v246 offset:45056
  v_mfma_f32_16x16x32_bf16 v[206:209], v[218:221], v[134:137], v[206:209]
  ds_read_b64_tr_b16 v[212:213], v246 offset:45824
  s_waitcnt lgkmcnt(11)
  v_mfma_f32_16x16x32_bf16 v[162:165], v[222:225], v[138:141], v[162:165]
  ds_read_b64_tr_b16 v[214:215], v247 offset:45088
  v_mfma_f32_16x16x32_bf16 v[166:169], v[222:225], v[142:145], v[166:169]
  ds_read_b64_tr_b16 v[216:217], v247 offset:45856
  v_mfma_f32_16x16x32_bf16 v[170:173], v[226:229], v[138:141], v[170:173]
  ds_read_b64_tr_b16 v[218:219], v246 offset:45120
  v_mfma_f32_16x16x32_bf16 v[174:177], v[226:229], v[142:145], v[174:177]
  ds_read_b64_tr_b16 v[220:221], v246 offset:45888
  s_waitcnt lgkmcnt(10)
  v_mfma_f32_16x16x32_bf16 v[178:181], v[230:233], v[138:141], v[178:181]
  ds_read_b64_tr_b16 v[222:223], v247 offset:45152
  v_mfma_f32_16x16x32_bf16 v[182:185], v[230:233], v[142:145], v[182:185]
  ds_read_b64_tr_b16 v[224:225], v247 offset:45920
  v_mfma_f32_16x16x32_bf16 v[186:189], v[234:237], v[138:141], v[186:189]
  ds_read_b64_tr_b16 v[226:227], v246 offset:45184
  v_mfma_f32_16x16x32_bf16 v[190:193], v[234:237], v[142:145], v[190:193]
  ds_read_b64_tr_b16 v[228:229], v246 offset:45952
  s_waitcnt lgkmcnt(10)
  v_mfma_f32_16x16x32_bf16 v[194:197], v[238:241], v[138:141], v[194:197]
  ds_read_b64_tr_b16 v[230:231], v247 offset:45216
  v_mfma_f32_16x16x32_bf16 v[198:201], v[238:241], v[142:145], v[198:201]
  ds_read_b64_tr_b16 v[232:233], v247 offset:45984
  v_mfma_f32_16x16x32_bf16 v[202:205], v[242:245], v[138:141], v[202:205]
  ds_read_b64_tr_b16 v[234:235], v246 offset:51200
  v_mfma_f32_16x16x32_bf16 v[206:209], v[242:245], v[142:145], v[206:209]
  ds_read_b64_tr_b16 v[236:237], v246 offset:51968
  s_waitcnt lgkmcnt(10)
  v_mfma_f32_16x16x32_bf16 v[162:165], v[210:213], v[146:149], v[162:165]
  ds_read_b64_tr_b16 v[238:239], v247 offset:51232
  v_mfma_f32_16x16x32_bf16 v[166:169], v[210:213], v[150:153], v[166:169]
  ds_read_b64_tr_b16 v[240:241], v247 offset:52000
  v_mfma_f32_16x16x32_bf16 v[170:173], v[214:217], v[146:149], v[170:173]
  ds_read_b64_tr_b16 v[242:243], v246 offset:51264
  v_mfma_f32_16x16x32_bf16 v[174:177], v[214:217], v[150:153], v[174:177]
  ds_read_b64_tr_b16 v[244:245], v246 offset:52032
  s_waitcnt lgkmcnt(10)
  v_mfma_f32_16x16x32_bf16 v[178:181], v[218:221], v[146:149], v[178:181]
  ds_read_b64_tr_b16 v[210:211], v247 offset:51296
  v_mfma_f32_16x16x32_bf16 v[182:185], v[218:221], v[150:153], v[182:185]
  ds_read_b64_tr_b16 v[212:213], v247 offset:52064
  v_mfma_f32_16x16x32_bf16 v[186:189], v[222:225], v[146:149], v[186:189]
  ds_read_b64_tr_b16 v[214:215], v246 offset:51328
  v_mfma_f32_16x16x32_bf16 v[190:193], v[222:225], v[150:153], v[190:193]
  ds_read_b64_tr_b16 v[216:217], v246 offset:52096
  s_waitcnt lgkmcnt(10)
  v_mfma_f32_16x16x32_bf16 v[194:197], v[226:229], v[146:149], v[194:197]
  ds_read_b64_tr_b16 v[218:219], v247 offset:51360
  v_mfma_f32_16x16x32_bf16 v[198:201], v[226:229], v[150:153], v[198:201]
  ds_read_b64_tr_b16 v[220:221], v247 offset:52128
  s_waitcnt vmcnt(0) lgkmcnt(0)
  s_barrier
  v_mfma_f32_16x16x32_bf16 v[202:205], v[230:233], v[146:149], v[202:205]
  v_mfma_f32_16x16x32_bf16 v[206:209], v[230:233], v[150:153], v[206:209]
  v_mfma_f32_16x16x32_bf16 v[162:165], v[234:237], v[154:157], v[162:165]
  v_mfma_f32_16x16x32_bf16 v[166:169], v[234:237], v[158:161], v[166:169]
  v_mfma_f32_16x16x32_bf16 v[170:173], v[238:241], v[154:157], v[170:173]
  v_mfma_f32_16x16x32_bf16 v[174:177], v[238:241], v[158:161], v[174:177]
  v_mfma_f32_16x16x32_bf16 v[178:181], v[242:245], v[154:157], v[178:181]
  v_mfma_f32_16x16x32_bf16 v[182:185], v[242:245], v[158:161], v[182:185]
  v_mfma_f32_16x16x32_bf16 v[186:189], v[210:213], v[154:157], v[186:189]
  v_mfma_f32_16x16x32_bf16 v[190:193], v[210:213], v[158:161], v[190:193]
  v_mfma_f32_16x16x32_bf16 v[194:197], v[214:217], v[154:157], v[194:197]
  v_mfma_f32_16x16x32_bf16 v[198:201], v[214:217], v[158:161], v[198:201]
  v_mfma_f32_16x16x32_bf16 v[202:205], v[218:221], v[154:157], v[202:205]
  v_mfma_f32_16x16x32_bf16 v[206:209], v[218:221], v[158:161], v[206:209]
  v_lshlrev_b32 v1, 4, v0
  v_and_b32 v112, 31, v0
  v_lshrrev_b32 v113, 5, v0
  v_and_b32 v114, 24, v112
  v_and_b32 v115, 3, v112
  v_lshl_add_u32 v114, v115, 1, v114
  v_bfe_u32 v115, v112, 2, 1
  v_add_u32 v114, v114, v115
  v_lshlrev_b32 v114, 3, v114
  v_lshl_add_u32 v2, v113, 8, v114
  v_mul_u32_u24 v115, 320, v113
  v_lshl_add_u32 v115, v112, 4, v115
  v_add_u32 v3, 1280, v115
  v_mov_b32 v4, 0xdddddddd
  s_mul_i32 s52, s44, 1280
  s_add_u32 s52, s52, 153600
  v_lshlrev_b32 v114, 3, v112
  v_lshl_add_u32 v114, v113, 8, v114
  v_add_u32 v7, s52, v114
  v_lshrrev_b32 v114, 1, v112
  v_and_b32 v115, 1, v112
  v_lshl_add_u32 v114, v115, 4, v114
  v_lshlrev_b32 v5, 4, v114
  v_lshlrev_b32 v6, 4, v112
  s_mov_b32 s60, 0x000fffff
  s_mov_b32 s61, 0x000fffff
  s_mov_b32 s62, -1
  s_mov_b32 s63, 0
  v_mov_b64 v[40:41], 0
  v_mov_b64 v[24:25], 0
  v_mov_b64 v[56:57], 0
  v_mov_b64 v[42:43], 0
  v_mov_b64 v[26:27], 0
  v_mov_b64 v[58:59], 0
  v_mov_b64 v[44:45], 0
  v_mov_b64 v[28:29], 0
  v_mov_b64 v[60:61], 0
  v_mov_b64 v[46:47], 0
  v_mov_b64 v[30:31], 0
  v_mov_b64 v[62:63], 0
  v_mov_b64 v[48:49], 0
  v_mov_b64 v[32:33], 0
  v_mov_b64 v[64:65], 0
  v_mov_b64 v[50:51], 0
  v_mov_b64 v[34:35], 0
  v_mov_b64 v[66:67], 0
  v_mov_b64 v[52:53], 0
  v_mov_b64 v[36:37], 0
  v_mov_b64 v[68:69], 0
  v_mov_b64 v[54:55], 0
  v_mov_b64 v[38:39], 0
  v_mov_b64 v[70:71], 0
  v_mov_b64 v[80:81], 0
  v_mov_b32 v82, 0x3f80
  v_mov_b32 v83, 0
  v_mov_b32 v112, 0x3f803f80
  v_mov_b32 v113, 0x3f803f80
  s_mov_b32 exec_lo, 0x01100000
  s_mov_b32 exec_hi, 0x01100000
  v_mov_b64 v[56:57], v[112:113]
  v_mov_b64 v[58:59], v[112:113]
  v_mov_b64 v[60:61], v[112:113]
  v_mov_b64 v[62:63], v[112:113]
  v_mov_b64 v[64:65], v[112:113]
  v_mov_b64 v[66:67], v[112:113]
  v_mov_b64 v[68:69], v[112:113]
  v_mov_b64 v[70:71], v[112:113]
  s_mov_b64 exec, -1
  v_cvt_pk_bf16_f32 v88, v162, v163
  v_cvt_pk_bf16_f32 v89, v164, v165
  v_cvt_pk_bf16_f32 v90, v170, v171
  v_cvt_pk_bf16_f32 v91, v172, v173
  v_pk_max_i16 v88, v88, 0
  v_pk_max_i16 v89, v89, 0
  v_pk_max_i16 v90, v90, 0
  v_pk_max_i16 v91, v91, 0
  v_cvt_pk_bf16_f32 v92, v166, v167
  v_cvt_pk_bf16_f32 v93, v168, v169
  v_cvt_pk_bf16_f32 v94, v174, v175
  v_cvt_pk_bf16_f32 v95, v176, v177
  v_pk_max_i16 v92, v92, 0
  v_pk_max_i16 v93, v93, 0
  v_pk_max_i16 v94, v94, 0
  v_pk_max_i16 v95, v95, 0
  v_cvt_pk_bf16_f32 v96, v178, v179
  v_cvt_pk_bf16_f32 v97, v180, v181
  v_cvt_pk_bf16_f32 v98, v186, v187
  v_cvt_pk_bf16_f32 v99, v188, v189
  v_pk_max_i16 v96, v96, 0
  v_pk_max_i16 v97, v97, 0
  v_pk_max_i16 v98, v98, 0
  v_pk_max_i16 v99, v99, 0
  v_cvt_pk_bf16_f32 v100, v182, v183
  v_cvt_pk_bf16_f32 v101, v184, v185
  v_cvt_pk_bf16_f32 v102, v190, v191
  v_cvt_pk_bf16_f32 v103, v192, v193
  v_pk_max_i16 v100, v100, 0
  v_pk_max_i16 v101, v101, 0
  v_pk_max_i16 v102, v102, 0
  v_pk_max_i16 v103, v103, 0
  v_cvt_pk_bf16_f32 v104, v194, v195
  v_cvt_pk_bf16_f32 v105, v196, v197
  v_cvt_pk_bf16_f32 v106, v202, v203
  v_cvt_pk_bf16_f32 v107, v204, v205
  v_pk_max_i16 v104, v104, 0
  v_pk_max_i16 v105, v105, 0
  v_pk_max_i16 v106, v106, 0
  v_pk_max_i16 v107, v107, 0
  v_cvt_pk_bf16_f32 v108, v198, v199
  v_cvt_pk_bf16_f32 v109, v200, v201
  v_cvt_pk_bf16_f32 v110, v206, v207
  v_cvt_pk_bf16_f32 v111, v208, v209
  v_pk_max_i16 v108, v108, 0
  v_pk_max_i16 v109, v109, 0
  v_pk_max_i16 v110, v110, 0
  v_pk_max_i16 v111, v111, 0
  v_mov_b32 v249, v248
  s_mov_b32 s6, s100
  s_mov_b32 s7, 256
  s_mov_b32 s8, 1792
  s_add_u32 s9, s100, 4352
  s_mov_b64 s[12:13], -1
  s_branch L_att
L_cons:
  s_setprio 1
  s_and_b32 s52, s2, 7
  s_lshr_b32 s53, s2, 6
  s_lshl2_add_u32 s48, s52, s53
  s_lshr_b32 s53, s2, 5
  s_lshl3_add_u32 s50, s52, s53
  s_and_b32 s51, s49, 3
  s_mul_i32 s52, s48, 1280
  s_mul_i32 s53, s48, 320
  s_add_u32 s52, s52, 0x280000
  s_add_u32 s53, s53, 0x500000
  v_add_u32 v228, 0, v0
  v_cmp_le_u32 vcc, 160, v228
  v_subrev_u32 v229, 160, v228
  v_mov_b32 v231, 0
  v_cndmask_b32 v228, v228, v229, vcc
  v_mov_b32 v232, 40960
  v_cndmask_b32 v231, v231, v232, vcc
  v_subrev_u32 v229, 80, v228
  v_mul_u32_u24 v230, 3277, v229
  v_lshrrev_b32 v230, 16, v230
  v_mul_u32_u24 v232, 9920, v230
  v_lshl_add_u32 v232, v229, 4, v232
  v_add_u32 v232, s53, v232
  v_cmp_gt_u32 vcc, 80, v228
  v_lshlrev_b32 v228, 4, v228
  v_add_u32 v228, s52, v228
  v_cndmask_b32 v228, v232, v228, vcc
  v_add_u32 v250, v228, v231
  v_add_u32 v228, 64, v0
  v_cmp_le_u32 vcc, 160, v228
  v_subrev_u32 v229, 160, v228
  v_mov_b32 v231, 0
  v_cndmask_b32 v228, v228, v229, vcc
  v_mov_b32 v232, 40960
  v_cndmask_b32 v231, v231, v232, vcc
  v_subrev_u32 v229, 80, v228
  v_mul_u32_u24 v230, 3277, v229
  v_lshrrev_b32 v230, 16, v230
  v_mul_u32_u24 v232, 9920, v230
  v_lshl_add_u32 v232, v229, 4, v232
  v_add_u32 v232, s53, v232
  v_cmp_gt_u32 vcc, 80, v228
  v_lshlrev_b32 v228, 4, v228
  v_add_u32 v228, s52, v228
  v_cndmask_b32 v228, v232, v228, vcc
  v_add_u32 v251, v228, v231
  v_add_u32 v228, 128, v0
  v_cmp_le_u32 vcc, 160, v228
  v_subrev_u32 v229, 160, v228
  v_mov_b32 v231, 0
  v_cndmask_b32 v228, v228, v229, vcc
  v_mov_b32 v232, 40960
  v_cndmask_b32 v231, v231, v232, vcc
  v_subrev_u32 v229, 80, v228
  v_mul_u32_u24 v230, 3277, v229
  v_lshrrev_b32 v230, 16, v230
  v_mul_u32_u24 v232, 9920, v230
  v_lshl_add_u32 v232, v229, 4, v232
  v_add_u32 v232, s53, v232
  v_cmp_gt_u32 vcc, 80, v228
  v_lshlrev_b32 v228, 4, v228
  v_add_u32 v228, s52, v228
  v_cndmask_b32 v228, v232, v228, vcc
  v_add_u32 v252, v228, v231
  v_add_u32 v228, 192, v0
  v_cmp_le_u32 vcc, 160, v228
  v_subrev_u32 v229, 160, v228
  v_mov_b32 v231, 0
  v_cndmask_b32 v228, v228, v229, vcc
  v_mov_b32 v232, 40960
  v_cndmask_b32 v231, v231, v232, vcc
  v_subrev_u32 v229, 80, v228
  v_mul_u32_u24 v230, 3277, v229
  v_lshrrev_b32 v230, 16, v230
  v_mul_u32_u24 v232, 9920, v230
  v_lshl_add_u32 v232, v229, 4, v232
  v_add_u32 v232, s53, v232
  v_cmp_gt_u32 vcc, 80, v228
  v_lshlrev_b32 v228, 4, v228
  v_add_u32 v228, s52, v228
  v_cndmask_b32 v228, v232, v228, vcc
  v_add_u32 v253, v228, v231
  v_add_u32 v228, 256, v0
  v_cmp_le_u32 vcc, 160, v228
  v_subrev_u32 v229, 160, v228
  v_mov_b32 v231, 0
  v_cndmask_b32 v228, v228, v229, vcc
  v_mov_b32 v232, 40960
  v_cndmask_b32 v231, v231, v232, vcc
  v_subrev_u32 v229, 80, v228
  v_mul_u32_u24 v230, 3277, v229
  v_lshrrev_b32 v230, 16, v230
  v_mul_u32_u24 v232, 9920, v230
  v_lshl_add_u32 v232, v229, 4, v232
  v_add_u32 v232, s53, v232
  v_cmp_gt_u32 vcc, 80, v228
  v_lshlrev_b32 v228, 4, v228
  v_add_u32 v228, s52, v228
  v_cndmask_b32 v228, v232, v228, vcc
  v_add_u32 v254, v228, v231
  s_waitcnt lgkmcnt(0)
  v_lshlrev_b32 v1, 4, v0
  v_and_b32 v228, 31, v0
  v_lshrrev_b32 v229, 5, v0
  v_and_b32 v230, 24, v228
  v_and_b32 v231, 3, v228
  v_lshl_add_u32 v230, v231, 1, v230
  v_bfe_u32 v231, v228, 2, 1
  v_add_u32 v230, v230, v231
  v_lshlrev_b32 v230, 3, v230
  v_lshl_add_u32 v2, v229, 8, v230
  v_mul_u32_u24 v231, 320, v229
  v_lshl_add_u32 v231, v228, 4, v231
  v_add_u32 v3, 1280, v231
  v_mov_b32 v4, 0xdddddddd
  s_mul_i32 s52, s44, 1280
  s_add_u32 s52, s52, 153600
  v_lshlrev_b32 v230, 3, v228
  v_lshl_add_u32 v230, v229, 8, v230
  v_add_u32 v7, s52, v230
  v_lshrrev_b32 v230, 1, v228
  v_and_b32 v231, 1, v228
  v_lshl_add_u32 v230, v231, 4, v230
  v_lshlrev_b32 v5, 4, v230
  v_lshlrev_b32 v6, 4, v228
  s_mov_b32 s60, 0x000fffff
  s_mov_b32 s61, 0x000fffff
  s_mov_b32 s62, -1
  s_mov_b32 s63, 0
  v_mov_b64 v[40:41], 0
  v_mov_b64 v[24:25], 0
  v_mov_b64 v[56:57], 0
  v_mov_b64 v[42:43], 0
  v_mov_b64 v[26:27], 0
  v_mov_b64 v[58:59], 0
  v_mov_b64 v[44:45], 0
  v_mov_b64 v[28:29], 0
  v_mov_b64 v[60:61], 0
  v_mov_b64 v[46:47], 0
  v_mov_b64 v[30:31], 0
  v_mov_b64 v[62:63], 0
  v_mov_b64 v[48:49], 0
  v_mov_b64 v[32:33], 0
  v_mov_b64 v[64:65], 0
  v_mov_b64 v[50:51], 0
  v_mov_b64 v[34:35], 0
  v_mov_b64 v[66:67], 0
  v_mov_b64 v[52:53], 0
  v_mov_b64 v[36:37], 0
  v_mov_b64 v[68:69], 0
  v_mov_b64 v[54:55], 0
  v_mov_b64 v[38:39], 0
  v_mov_b64 v[70:71], 0
  v_mov_b64 v[80:81], 0
  v_mov_b32 v82, 0x3f80
  v_mov_b32 v83, 0
  v_mov_b32 v228, 0x3f803f80
  v_mov_b32 v229, 0x3f803f80
  s_mov_b32 exec_lo, 0x01100000
  s_mov_b32 exec_hi, 0x01100000
  v_mov_b64 v[56:57], v[228:229]
  v_mov_b64 v[58:59], v[228:229]
  v_mov_b64 v[60:61], v[228:229]
  v_mov_b64 v[62:63], v[228:229]
  v_mov_b64 v[64:65], v[228:229]
  v_mov_b64 v[66:67], v[228:229]
  v_mov_b64 v[68:69], v[228:229]
  v_mov_b64 v[70:71], v[228:229]
  s_mov_b64 exec, -1
  s_lshl_b32 s3, s44, 8
  s_add_u32 s3, s3, s2
  s_cmp_lt_u32 s3, 384
  s_cbranch_scc0 L_pfwod
  s_lshr_b32 s52, s3, 2
  s_and_b32 s55, s3, 3
  s_branch L_pfgod
L_pfwod:
  s_sub_u32 s52, s3, 384
  s_and_b32 s55, s52, 3
  s_lshr_b32 s52, s52, 2
  s_add_u32 s52, s52, 96
L_pfgod:
  s_mul_i32 s53, s55, 680
  s_add_u32 s53, s53, s52
  s_lshl_b32 s100, s53, 10
  s_add_u32 s100, s100, 0x1010000
  s_cmp_lt_u32 s3, 544
  s_cselect_b32 s100, s100, 0x10000000
  s_cmp_eq_u32 s44, 1
  s_mov_b32 s57, 57344
  s_cmov_b32 s57, 90112
  s_cmp_eq_u32 s44, 2
  s_cmov_b32 s57, 122880
  s_lshl_b32 s52, s45, 7
  s_lshl_b32 s53, s46, 3
  s_add_u32 s52, s52, s53
  s_lshl_b32 s53, s44, 1
  s_add_u32 s101, s52, s53
  s_mul_i32 s11, s101, 1280
  s_lshl_b32 s101, s101, 4
  s_add_u32 s101, s101, 0x1000000
  v_and_b32 v236, 31, v0
  v_lshrrev_b32 v237, 5, v0
  v_lshlrev_b32 v160, 4, v236
  v_lshlrev_b32 v161, 3, v236
  v_mul_u32_u24 v240, 1280, v237
  v_add_u32 v158, v240, v160
  v_add_u32 v159, v240, v161
  v_lshlrev_b32 v162, 4, v237
  v_bfe_u32 v239, v0, 2, 2
  v_lshl_add_u32 v239, v237, 2, v239
  v_mul_u32_u24 v239, 320, v239
  v_bfe_u32 v240, v0, 4, 1
  v_lshl_add_u32 v239, v240, 4, v239
  v_and_b32 v240, 1, v0
  v_lshl_add_u32 v239, v240, 5, v239
  v_bfe_u32 v240, v0, 1, 1
  v_lshl_add_u32 v239, v240, 3, v239
  v_add_u32 v230, s57, v239
  s_lshr_b32 s58, s44, 1
  s_and_b32 s3, s44, 1
  s_mul_i32 s47, s46, 52
  s_lshr_b32 s47, s47, 8
  v_and_b32 v240, 15, v0
  v_lshrrev_b32 v241, 4, v0
  v_lshrrev_b32 v236, 1, v240
  v_xor_b32 v236, v236, v241
  v_lshlrev_b32 v236, 4, v236
  v_lshl_add_u32 v242, v240, 7, v236
  v_bfe_u32 v236, v0, 2, 2
  v_lshl_add_u32 v243, v241, 3, v236
  s_lshl_b32 s52, s58, 13
  v_add_u32 v244, s52, v242
  v_xor_b32 v245, 64, v244
  v_and_b32 v237, 1, v241
  v_lshl_add_u32 v236, v237, 2, v236
  s_lshl_b32 s52, s3, 2
  v_xor_b32 v236, s52, v236
  v_and_b32 v237, 3, v0
  v_lshlrev_b32 v237, 3, v237
  v_lshl_add_u32 v237, v243, 8, v237
  v_add_u32 v237, 16384, v237
  v_xor_b32 v238, 0, v236
  v_lshl_add_u32 v246, v238, 5, v237
  v_xor_b32 v238, 1, v236
  v_lshl_add_u32 v247, v238, 5, v237
  v_xor_b32 v238, 2, v236
  v_lshl_add_u32 v248, v238, 5, v237
  v_xor_b32 v238, 3, v236
  v_lshl_add_u32 v249, v238, 5, v237
  s_mul_i32 s54, s47, 0x280000
  s_lshl_b32 s52, s45, 2
  s_lshl_b32 s53, s58, 1
  s_add_u32 s52, s52, s53
  s_mul_i32 s52, s52, 40960
  s_add_u32 s54, s54, s52
  s_mul_i32 s52, s47, 5
  s_sub_u32 s52, s46, s52
  s_lshl_b32 s52, s52, 3
  s_lshl_b32 s53, s3, 2
  s_add_u32 s52, s52, s53
  s_cmp_eq_u32 s47, 2
  s_mov_b32 s55, 1024
  s_cmov_b32 s55, 256
  s_mov_b32 s53, 256
  s_cmov_b32 s53, 10240
  s_mul_i32 s52, s52, s55
  s_add_u32 s96, s52, s54
  s_cmp_eq_u32 s46, 15
  s_cmov_b32 s96, 0x10000000
  s_add_u32 s97, s96, s55
  s_add_u32 s98, s97, s55
  s_add_u32 s99, s98, s55
  v_mul_u32_u24 v228, s53, v241
  v_lshl_add_u32 v228, v240, 4, v228
  v_add_u32 v229, 40960, v228
  s_cmp_eq_u32 s47, 0
  s_cselect_b32 s56, 0x3ea52b5c, 1.0
  s_mov_b32 s57, s56
  v_mov_b64 v[164:165], 0
  v_mov_b64 v[166:167], 0
  v_mov_b64 v[168:169], 0
  v_mov_b64 v[170:171], 0
  v_mov_b64 v[172:173], 0
  v_mov_b64 v[174:175], 0
  v_mov_b64 v[176:177], 0
  v_mov_b64 v[178:179], 0
  v_mov_b64 v[180:181], 0
  v_mov_b64 v[182:183], 0
  v_mov_b64 v[184:185], 0
  v_mov_b64 v[186:187], 0
  v_mov_b64 v[188:189], 0
  v_mov_b64 v[190:191], 0
  v_mov_b64 v[192:193], 0
  v_mov_b64 v[194:195], 0
  v_mov_b64 v[196:197], 0
  v_mov_b64 v[198:199], 0
  v_mov_b64 v[200:201], 0
  v_mov_b64 v[202:203], 0
  v_mov_b64 v[204:205], 0
  v_mov_b64 v[206:207], 0
  v_mov_b64 v[208:209], 0
  v_mov_b64 v[210:211], 0
  v_mov_b64 v[212:213], 0
  v_mov_b64 v[214:215], 0
  v_mov_b64 v[216:217], 0
  v_mov_b64 v[218:219], 0
  v_mov_b64 v[220:221], 0
  v_mov_b64 v[222:223], 0
  v_mov_b64 v[224:225], 0
  v_mov_b64 v[226:227], 0
  s_lshl_b32 s10, s46, 11
  s_add_u32 s10, s10, 0x12c0000
  s_mov_b32 s24, s22
  s_mov_b32 s25, s23
  s_mov_b32 s26, 0x1400000
  s_mov_b32 s27, 0x20000
  s_mov_b32 s30, 0x280000
  s_mov_b32 s31, 0x20000
  s_mov_b32 s40, s16
  s_mov_b32 s41, s17
  s_mov_b32 s42, 0x500
  s_mov_b32 s43, 0x20000
  s_mov_b32 s36, s20
  s_mov_b32 s37, s21
  s_mov_b32 s38, 0x100
  s_mov_b32 s39, 0x20000
  s_lshl_b32 s3, s44, 8
  s_add_u32 s3, s3, s2
  s_cmp_lt_u32 s3, 384
  s_cselect_b32 s32, s14, s8
  s_cselect_b32 s33, s15, s9
  s_mov_b32 s34, 819200
  s_cmov_b32 s34, 1966080
  s_mov_b32 s35, 0x20000
  s_cbranch_scc0 L_pfwos
  s_lshr_b32 s52, s3, 2
  s_and_b32 s55, s3, 3
  s_lshr_b32 s53, s52, 1
  s_lshl_b32 s53, s53, 5
  s_and_b32 s54, s52, 1
  s_lshl_b32 s54, s54, 3
  s_add_u32 s5, s53, s54
  s_mov_b32 s6, 16
  s_mov_b32 s7, 4
  s_branch L_pfgos
L_pfwos:
  s_sub_u32 s52, s3, 384
  s_and_b32 s55, s52, 3
  s_lshr_b32 s52, s52, 2
  s_mul_i32 s53, s52, 20
  s_mul_i32 s54, s52, 80
  s_sub_u32 s54, s54, 2544
  s_cmp_lt_u32 s52, 32
  s_cselect_b32 s5, s53, s54
  s_cselect_b32 s6, 8, 20
  s_cselect_b32 s7, 4, 40
  s_add_u32 s52, s52, 96
L_pfgos:
  s_cmp_eq_u32 s44, 1
  s_mov_b32 s9, 57344
  s_cmov_b32 s9, 90112
  s_cmp_eq_u32 s44, 2
  s_cmov_b32 s9, 122880
  s_mul_i32 s5, s5, 1280
  s_mul_i32 s55, s55, 320
  s_add_u32 s5, s5, s55
  s_cmp_lt_u32 s3, 544
  s_cselect_b32 s5, s5, 0x10000000
  s_cmp_eq_u32 s44, 3
  s_cmov_b32 s9, 128000
  s_cselect_b32 s8, 0, 1024
  v_add_u32 v236, 0, v0
  v_mul_u32_u24 v237, 3277, v236
  v_lshrrev_b32 v237, 16, v237
  v_mul_u32_u24 v238, 20, v237
  v_sub_u32 v238, v236, v238
  v_lshrrev_b32 v239, 3, v237
  v_mul_u32_u24 v239, s6, v239
  v_bfe_u32 v240, v237, 2, 1
  v_mul_u32_u24 v240, s7, v240
  v_and_b32 v237, 3, v237
  v_add3_u32 v237, v237, v239, v240
  v_mul_u32_u24 v237, 1280, v237
  v_lshl_add_u32 v231, v238, 4, v237
  v_add_u32 v236, 64, v0
  v_mul_u32_u24 v237, 3277, v236
  v_lshrrev_b32 v237, 16, v237
  v_mul_u32_u24 v238, 20, v237
  v_sub_u32 v238, v236, v238
  v_lshrrev_b32 v239, 3, v237
  v_mul_u32_u24 v239, s6, v239
  v_bfe_u32 v240, v237, 2, 1
  v_mul_u32_u24 v240, s7, v240
  v_and_b32 v237, 3, v237
  v_add3_u32 v237, v237, v239, v240
  v_mul_u32_u24 v237, 1280, v237
  v_lshl_add_u32 v232, v238, 4, v237
  v_add_u32 v236, 128, v0
  v_mul_u32_u24 v237, 3277, v236
  v_lshrrev_b32 v237, 16, v237
  v_mul_u32_u24 v238, 20, v237
  v_sub_u32 v238, v236, v238
  v_lshrrev_b32 v239, 3, v237
  v_mul_u32_u24 v239, s6, v239
  v_bfe_u32 v240, v237, 2, 1
  v_mul_u32_u24 v240, s7, v240
  v_and_b32 v237, 3, v237
  v_add3_u32 v237, v237, v239, v240
  v_mul_u32_u24 v237, 1280, v237
  v_lshl_add_u32 v233, v238, 4, v237
  v_add_u32 v236, 192, v0
  v_mul_u32_u24 v237, 3277, v236
  v_lshrrev_b32 v237, 16, v237
  v_mul_u32_u24 v238, 20, v237
  v_sub_u32 v238, v236, v238
  v_lshrrev_b32 v239, 3, v237
  v_mul_u32_u24 v239, s6, v239
  v_bfe_u32 v240, v237, 2, 1
  v_mul_u32_u24 v240, s7, v240
  v_and_b32 v237, 3, v237
  v_add3_u32 v237, v237, v239, v240
  v_mul_u32_u24 v237, 1280, v237
  v_lshl_add_u32 v234, v238, 4, v237
  v_add_u32 v236, 256, v0
  v_mul_u32_u24 v237, 3277, v236
  v_lshrrev_b32 v237, 16, v237
  v_mul_u32_u24 v238, 20, v237
  v_sub_u32 v238, v236, v238
  v_lshrrev_b32 v239, 3, v237
  v_mul_u32_u24 v239, s6, v239
  v_bfe_u32 v240, v237, 2, 1
  v_mul_u32_u24 v240, s7, v240
  v_and_b32 v237, 3, v237
  v_add3_u32 v237, v237, v239, v240
  v_mul_u32_u24 v237, 1280, v237
  v_lshl_add_u32 v235, v238, 4, v237
  s_cmp_lg_u32 s2, 198
  s_cselect_b32 s52, 1, s44
  s_cmp_lg_u32 s52, 0
  s_cbranch_scc1 L_noclr
  v_lshlrev_b32 v236, 8, v0
  v_mov_b32 v237, 0
  s_mov_b32 s52, 0x12c0000
  buffer_store_dword v237, v236, s[24:27], s52 offen sc1
  s_add_u32 s52, s52, 16384
  buffer_store_dword v237, v236, s[24:27], s52 offen sc1
  s_add_u32 s52, s52, 16384
  buffer_store_dword v237, v236, s[24:27], s52 offen sc1
  s_add_u32 s52, s52, 16384
  buffer_store_dword v237, v236, s[24:27], s52 offen sc1
  s_add_u32 s52, s52, 16384
  buffer_store_dword v237, v236, s[24:27], s52 offen sc1
  v_mov_b32 v236, 1
  s_waitcnt vmcnt(0)
  s_mov_b64 exec, 1
  buffer_store_dword v236, v237, s[36:39], 0 offen sc1
  s_mov_b64 exec, -1
L_noclr:
  s_mov_b32 s59, 5
  s_barrier
  ds_read_b128 v[84:87], v244 offset:0
  ds_read_b64_tr_b16 v[116:117], v246 offset:0
  ds_read_b64_tr_b16 v[118:119], v246 offset:1024
  ds_read_b128 v[88:91], v244 offset:2048
  ds_read_b128 v[92:95], v244 offset:4096
  ds_read_b128 v[96:99], v244 offset:6144
  ds_read_b64_tr_b16 v[120:121], v247 offset:0
  ds_read_b64_tr_b16 v[122:123], v247 offset:1024
  ds_read_b64_tr_b16 v[124:125], v248 offset:0
  ds_read_b64_tr_b16 v[126:127], v248 offset:1024
  ds_read_b64_tr_b16 v[128:129], v249 offset:0
  ds_read_b64_tr_b16 v[130:131], v249 offset:1024
  s_cmp_eq_u32 s47, 2
  s_cbranch_scc1 L_loopv
.p2align 3
L_loopn:
  s_waitcnt lgkmcnt(6)
  v_mfma_f32_16x16x32_bf16 v[164:167], v[116:119], v[84:87], v[164:167]
  ds_read_b128 v[100:103], v245 offset:0
  v_mfma_f32_16x16x32_bf16 v[168:171], v[116:119], v[88:91], v[168:171]
  ds_read_b64_tr_b16 v[132:133], v246 offset:8192
  v_mfma_f32_16x16x32_bf16 v[172:175], v[116:119], v[92:95], v[172:175]
  ds_read_b64_tr_b16 v[134:135], v246 offset:9216
  v_mfma_f32_16x16x32_bf16 v[176:179], v[116:119], v[96:99], v[176:179]
  ds_read_b128 v[104:107], v245 offset:2048
  s_waitcnt lgkmcnt(4)
  v_mfma_f32_16x16x32_bf16 v[180:183], v[120:123], v[84:87], v[180:183]
  ds_read_b128 v[108:111], v245 offset:4096
  v_mfma_f32_16x16x32_bf16 v[184:187], v[120:123], v[88:91], v[184:187]
  ds_read_b128 v[112:115], v245 offset:6144
  v_mfma_f32_16x16x32_bf16 v[188:191], v[120:123], v[92:95], v[188:191]
  ds_read_b64_tr_b16 v[136:137], v247 offset:8192
  v_mfma_f32_16x16x32_bf16 v[192:195], v[120:123], v[96:99], v[192:195]
  ds_read_b64_tr_b16 v[138:139], v247 offset:9216
  v_mfma_f32_16x16x32_bf16 v[196:199], v[124:127], v[84:87], v[196:199]
  ds_read_b64_tr_b16 v[140:141], v248 offset:8192
  v_mfma_f32_16x16x32_bf16 v[200:203], v[124:127], v[88:91], v[200:203]
  ds_read_b64_tr_b16 v[142:143], v248 offset:9216
  v_mfma_f32_16x16x32_bf16 v[204:207], v[124:127], v[92:95], v[204:207]
  ds_read_b64_tr_b16 v[144:145], v249 offset:8192
  v_mfma_f32_16x16x32_bf16 v[208:211], v[124:127], v[96:99], v[208:211]
  ds_read_b64_tr_b16 v[146:147], v249 offset:9216
  v_mfma_f32_16x16x32_bf16 v[212:215], v[128:131], v[84:87], v[212:215]
  s_sub_u32 s59, s59, 1
  v_mfma_f32_16x16x32_bf16 v[216:219], v[128:131], v[88:91], v[216:219]
  v_mfma_f32_16x16x32_bf16 v[220:223], v[128:131], v[92:95], v[220:223]
  v_mfma_f32_16x16x32_bf16 v[224:227], v[128:131], v[96:99], v[224:227]
  s_waitcnt lgkmcnt(0)
  s_barrier
  v_mfma_f32_16x16x32_bf16 v[164:167], v[132:135], v[100:103], v[164:167]
  ds_read_b128 v[84:87], v244 offset:32768
  v_mfma_f32_16x16x32_bf16 v[168:171], v[132:135], v[104:107], v[168:171]
  ds_read_b64_tr_b16 v[116:117], v246 offset:32768
  v_mfma_f32_16x16x32_bf16 v[172:175], v[132:135], v[108:111], v[172:175]
  ds_read_b64_tr_b16 v[118:119], v246 offset:33792
  v_mfma_f32_16x16x32_bf16 v[176:179], v[132:135], v[112:115], v[176:179]
  ds_read_b128 v[88:91], v244 offset:34816
  v_mfma_f32_16x16x32_bf16 v[180:183], v[136:139], v[100:103], v[180:183]
  ds_read_b128 v[92:95], v244 offset:36864
  v_mfma_f32_16x16x32_bf16 v[184:187], v[136:139], v[104:107], v[184:187]
  ds_read_b128 v[96:99], v244 offset:38912
  v_mfma_f32_16x16x32_bf16 v[188:191], v[136:139], v[108:111], v[188:191]
  ds_read_b64_tr_b16 v[120:121], v247 offset:32768
  v_mfma_f32_16x16x32_bf16 v[192:195], v[136:139], v[112:115], v[192:195]
  ds_read_b64_tr_b16 v[122:123], v247 offset:33792
  v_mfma_f32_16x16x32_bf16 v[196:199], v[140:143], v[100:103], v[196:199]
  ds_read_b64_tr_b16 v[124:125], v248 offset:32768
  v_mfma_f32_16x16x32_bf16 v[200:203], v[140:143], v[104:107], v[200:203]
  ds_read_b64_tr_b16 v[126:127], v248 offset:33792
  v_mfma_f32_16x16x32_bf16 v[204:207], v[140:143], v[108:111], v[204:207]
  ds_read_b64_tr_b16 v[128:129], v249 offset:32768
  v_mfma_f32_16x16x32_bf16 v[208:211], v[140:143], v[112:115], v[208:211]
  ds_read_b64_tr_b16 v[130:131], v249 offset:33792
  v_mfma_f32_16x16x32_bf16 v[212:215], v[144:147], v[100:103], v[212:215]
  v_mfma_f32_16x16x32_bf16 v[216:219], v[144:147], v[104:107], v[216:219]
  v_mfma_f32_16x16x32_bf16 v[220:223], v[144:147], v[108:111], v[220:223]
  v_mfma_f32_16x16x32_bf16 v[224:227], v[144:147], v[112:115], v[224:227]
  s_waitcnt lgkmcnt(6)
  v_mfma_f32_16x16x32_bf16 v[164:167], v[116:119], v[84:87], v[164:167]
  ds_read_b128 v[100:103], v245 offset:32768
  v_mfma_f32_16x16x32_bf16 v[168:171], v[116:119], v[88:91], v[168:171]
  ds_read_b64_tr_b16 v[132:133], v246 offset:40960
  v_mfma_f32_16x16x32_bf16 v[172:175], v[116:119], v[92:95], v[172:175]
  ds_read_b64_tr_b16 v[134:135], v246 offset:41984
  v_mfma_f32_16x16x32_bf16 v[176:179], v[116:119], v[96:99], v[176:179]
  ds_read_b128 v[104:107], v245 offset:34816
  s_waitcnt lgkmcnt(4)
  v_mfma_f32_16x16x32_bf16 v[180:183], v[120:123], v[84:87], v[180:183]
  ds_read_b128 v[108:111], v245 offset:36864
  v_mfma_f32_16x16x32_bf16 v[184:187], v[120:123], v[88:91], v[184:187]
  ds_read_b128 v[112:115], v245 offset:38912
  v_mfma_f32_16x16x32_bf16 v[188:191], v[120:123], v[92:95], v[188:191]
  ds_read_b64_tr_b16 v[136:137], v247 offset:40960
  v_mfma_f32_16x16x32_bf16 v[192:195], v[120:123], v[96:99], v[192:195]
  ds_read_b64_tr_b16 v[138:139], v247 offset:41984
  v_mfma_f32_16x16x32_bf16 v[196:199], v[124:127], v[84:87], v[196:199]
  ds_read_b64_tr_b16 v[140:141], v248 offset:40960
  v_mfma_f32_16x16x32_bf16 v[200:203], v[124:127], v[88:91], v[200:203]
  ds_read_b64_tr_b16 v[142:143], v248 offset:41984
  v_mfma_f32_16x16x32_bf16 v[204:207], v[124:127], v[92:95], v[204:207]
  ds_read_b64_tr_b16 v[144:145], v249 offset:40960
  v_mfma_f32_16x16x32_bf16 v[208:211], v[124:127], v[96:99], v[208:211]
  ds_read_b64_tr_b16 v[146:147], v249 offset:41984
  v_mfma_f32_16x16x32_bf16 v[212:215], v[128:131], v[84:87], v[212:215]
  v_xor_b32 v244, 0x10000, v244
  v_xor_b32 v246, 0x10000, v246
  v_mfma_f32_16x16x32_bf16 v[216:219], v[128:131], v[88:91], v[216:219]
  v_xor_b32 v247, 0x10000, v247
  v_xor_b32 v248, 0x10000, v248
  v_mfma_f32_16x16x32_bf16 v[220:223], v[128:131], v[92:95], v[220:223]
  v_xor_b32 v249, 0x10000, v249
  v_xor_b32 v245, 0x10000, v245
  v_mfma_f32_16x16x32_bf16 v[224:227], v[128:131], v[96:99], v[224:227]
  s_waitcnt lgkmcnt(0)
  s_barrier
  v_mfma_f32_16x16x32_bf16 v[164:167], v[132:135], v[100:103], v[164:167]
  ds_read_b128 v[84:87], v244 offset:0
  v_mfma_f32_16x16x32_bf16 v[168:171], v[132:135], v[104:107], v[168:171]
  ds_read_b64_tr_b16 v[116:117], v246 offset:0
  v_mfma_f32_16x16x32_bf16 v[172:175], v[132:135], v[108:111], v[172:175]
  ds_read_b64_tr_b16 v[118:119], v246 offset:1024
  v_mfma_f32_16x16x32_bf16 v[176:179], v[132:135], v[112:115], v[176:179]
  ds_read_b128 v[88:91], v244 offset:2048
  v_mfma_f32_16x16x32_bf16 v[180:183], v[136:139], v[100:103], v[180:183]
  ds_read_b128 v[92:95], v244 offset:4096
  v_mfma_f32_16x16x32_bf16 v[184:187], v[136:139], v[104:107], v[184:187]
  ds_read_b128 v[96:99], v244 offset:6144
  v_mfma_f32_16x16x32_bf16 v[188:191], v[136:139], v[108:111], v[188:191]
  ds_read_b64_tr_b16 v[120:121], v247 offset:0
  v_mfma_f32_16x16x32_bf16 v[192:195], v[136:139], v[112:115], v[192:195]
  ds_read_b64_tr_b16 v[122:123], v247 offset:1024
  v_mfma_f32_16x16x32_bf16 v[196:199], v[140:143], v[100:103], v[196:199]
  ds_read_b64_tr_b16 v[124:125], v248 offset:0
  v_mfma_f32_16x16x32_bf16 v[200:203], v[140:143], v[104:107], v[200:203]
  ds_read_b64_tr_b16 v[126:127], v248 offset:1024
  v_mfma_f32_16x16x32_bf16 v[204:207], v[140:143], v[108:111], v[204:207]
  ds_read_b64_tr_b16 v[128:129], v249 offset:0
  v_mfma_f32_16x16x32_bf16 v[208:211], v[140:143], v[112:115], v[208:211]
  ds_read_b64_tr_b16 v[130:131], v249 offset:1024
  v_mfma_f32_16x16x32_bf16 v[212:215], v[144:147], v[100:103], v[212:215]
  v_mfma_f32_16x16x32_bf16 v[216:219], v[144:147], v[104:107], v[216:219]
  v_mfma_f32_16x16x32_bf16 v[220:223], v[144:147], v[108:111], v[220:223]
  v_mfma_f32_16x16x32_bf16 v[224:227], v[144:147], v[112:115], v[224:227]
  s_cmp_lg_u32 s59, 0
  s_cbranch_scc1 L_loopn
  s_branch L_epi1
.p2align 3
L_loopv:
  s_waitcnt lgkmcnt(6)
  v_mfma_f32_16x16x32_bf16 v[164:167], v[84:87], v[116:119], v[164:167]
  ds_read_b128 v[100:103], v245 offset:0
  v_mfma_f32_16x16x32_bf16 v[168:171], v[88:91], v[116:119], v[168:171]
  ds_read_b64_tr_b16 v[132:133], v246 offset:8192
  v_mfma_f32_16x16x32_bf16 v[172:175], v[92:95], v[116:119], v[172:175]
  ds_read_b64_tr_b16 v[134:135], v246 offset:9216
  v_mfma_f32_16x16x32_bf16 v[176:179], v[96:99], v[116:119], v[176:179]
  ds_read_b128 v[104:107], v245 offset:2048
  s_waitcnt lgkmcnt(4)
  v_mfma_f32_16x16x32_bf16 v[180:183], v[84:87], v[120:123], v[180:183]
  ds_read_b128 v[108:111], v245 offset:4096
  v_mfma_f32_16x16x32_bf16 v[184:187], v[88:91], v[120:123], v[184:187]
  ds_read_b128 v[112:115], v245 offset:6144
  v_mfma_f32_16x16x32_bf16 v[188:191], v[92:95], v[120:123], v[188:191]
  ds_read_b64_tr_b16 v[136:137], v247 offset:8192
  v_mfma_f32_16x16x32_bf16 v[192:195], v[96:99], v[120:123], v[192:195]
  ds_read_b64_tr_b16 v[138:139], v247 offset:9216
  v_mfma_f32_16x16x32_bf16 v[196:199], v[84:87], v[124:127], v[196:199]
  ds_read_b64_tr_b16 v[140:141], v248 offset:8192
  v_mfma_f32_16x16x32_bf16 v[200:203], v[88:91], v[124:127], v[200:203]
  ds_read_b64_tr_b16 v[142:143], v248 offset:9216
  v_mfma_f32_16x16x32_bf16 v[204:207], v[92:95], v[124:127], v[204:207]
  ds_read_b64_tr_b16 v[144:145], v249 offset:8192
  v_mfma_f32_16x16x32_bf16 v[208:211], v[96:99], v[124:127], v[208:211]
  ds_read_b64_tr_b16 v[146:147], v249 offset:9216
  v_mfma_f32_16x16x32_bf16 v[212:215], v[84:87], v[128:131], v[212:215]
  s_sub_u32 s59, s59, 1
  v_mfma_f32_16x16x32_bf16 v[216:219], v[88:91], v[128:131], v[216:219]
  v_mfma_f32_16x16x32_bf16 v[220:223], v[92:95], v[128:131], v[220:223]
  v_mfma_f32_16x16x32_bf16 v[224:227], v[96:99], v[128:131], v[224:227]
  s_waitcnt lgkmcnt(0)
  s_barrier
  v_mfma_f32_16x16x32_bf16 v[164:167], v[100:103], v[132:135], v[164:167]
  ds_read_b128 v[84:87], v244 offset:32768
  v_mfma_f32_16x16x32_bf16 v[168:171], v[104:107], v[132:135], v[168:171]
  ds_read_b64_tr_b16 v[116:117], v246 offset:32768
  v_mfma_f32_16x16x32_bf16 v[172:175], v[108:111], v[132:135], v[172:175]
  ds_read_b64_tr_b16 v[118:119], v246 offset:33792
  v_mfma_f32_16x16x32_bf16 v[176:179], v[112:115], v[132:135], v[176:179]
  ds_read_b128 v[88:91], v244 offset:34816
  v_mfma_f32_16x16x32_bf16 v[180:183], v[100:103], v[136:139], v[180:183]
  ds_read_b128 v[92:95], v244 offset:36864
  v_mfma_f32_16x16x32_bf16 v[184:187], v[104:107], v[136:139], v[184:187]
  ds_read_b128 v[96:99], v244 offset:38912
  v_mfma_f32_16x16x32_bf16 v[188:191], v[108:111], v[136:139], v[188:191]
  ds_read_b64_tr_b16 v[120:121], v247 offset:32768
  v_mfma_f32_16x16x32_bf16 v[192:195], v[112:115], v[136:139], v[192:195]
  ds_read_b64_tr_b16 v[122:123], v247 offset:33792
  v_mfma_f32_16x16x32_bf16 v[196:199], v[100:103], v[140:143], v[196:199]
  ds_read_b64_tr_b16 v[124:125], v248 offset:32768
  v_mfma_f32_16x16x32_bf16 v[200:203], v[104:107], v[140:143], v[200:203]
  ds_read_b64_tr_b16 v[126:127], v248 offset:33792
  v_mfma_f32_16x16x32_bf16 v[204:207], v[108:111], v[140:143], v[204:207]
  ds_read_b64_tr_b16 v[128:129], v249 offset:32768
  v_mfma_f32_16x16x32_bf16 v[208:211], v[112:115], v[140:143], v[208:211]
  ds_read_b64_tr_b16 v[130:131], v249 offset:33792
  v_mfma_f32_16x16x32_bf16 v[212:215], v[100:103], v[144:147], v[212:215]
  v_mfma_f32_16x16x32_bf16 v[216:219], v[104:107], v[144:147], v[216:219]
  v_mfma_f32_16x16x32_bf16 v[220:223], v[108:111], v[144:147], v[220:223]
  v_mfma_f32_16x16x32_bf16 v[224:227], v[112:115], v[144:147], v[224:227]
  s_waitcnt lgkmcnt(6)
  v_mfma_f32_16x16x32_bf16 v[164:167], v[84:87], v[116:119], v[164:167]
  ds_read_b128 v[100:103], v245 offset:32768
  v_mfma_f32_16x16x32_bf16 v[168:171], v[88:91], v[116:119], v[168:171]
  ds_read_b64_tr_b16 v[132:133], v246 offset:40960
  v_mfma_f32_16x16x32_bf16 v[172:175], v[92:95], v[116:119], v[172:175]
  ds_read_b64_tr_b16 v[134:135], v246 offset:41984
  v_mfma_f32_16x16x32_bf16 v[176:179], v[96:99], v[116:119], v[176:179]
  ds_read_b128 v[104:107], v245 offset:34816
  s_waitcnt lgkmcnt(4)
  v_mfma_f32_16x16x32_bf16 v[180:183], v[84:87], v[120:123], v[180:183]
  ds_read_b128 v[108:111], v245 offset:36864
  v_mfma_f32_16x16x32_bf16 v[184:187], v[88:91], v[120:123], v[184:187]
  ds_read_b128 v[112:115], v245 offset:38912
  v_mfma_f32_16x16x32_bf16 v[188:191], v[92:95], v[120:123], v[188:191]
  ds_read_b64_tr_b16 v[136:137], v247 offset:40960
  v_mfma_f32_16x16x32_bf16 v[192:195], v[96:99], v[120:123], v[192:195]
  ds_read_b64_tr_b16 v[138:139], v247 offset:41984
  v_mfma_f32_16x16x32_bf16 v[196:199], v[84:87], v[124:127], v[196:199]
  ds_read_b64_tr_b16 v[140:141], v248 offset:40960
  v_mfma_f32_16x16x32_bf16 v[200:203], v[88:91], v[124:127], v[200:203]
  ds_read_b64_tr_b16 v[142:143], v248 offset:41984
  v_mfma_f32_16x16x32_bf16 v[204:207], v[92:95], v[124:127], v[204:207]
  ds_read_b64_tr_b16 v[144:145], v249 offset:40960
  v_mfma_f32_16x16x32_bf16 v[208:211], v[96:99], v[124:127], v[208:211]
  ds_read_b64_tr_b16 v[146:147], v249 offset:41984
  v_mfma_f32_16x16x32_bf16 v[212:215], v[84:87], v[128:131], v[212:215]
  v_xor_b32 v244, 0x10000, v244
  v_xor_b32 v246, 0x10000, v246
  v_mfma_f32_16x16x32_bf16 v[216:219], v[88:91], v[128:131], v[216:219]
  v_xor_b32 v247, 0x10000, v247
  v_xor_b32 v248, 0x10000, v248
  v_mfma_f32_16x16x32_bf16 v[220:223], v[92:95], v[128:131], v[220:223]
  v_xor_b32 v249, 0x10000, v249
  v_xor_b32 v245, 0x10000, v245
  v_mfma_f32_16x16x32_bf16 v[224:227], v[96:99], v[128:131], v[224:227]
  s_waitcnt lgkmcnt(0)
  s_barrier
  v_mfma_f32_16x16x32_bf16 v[164:167], v[100:103], v[132:135], v[164:167]
  ds_read_b128 v[84:87], v244 offset:0
  v_mfma_f32_16x16x32_bf16 v[168:171], v[104:107], v[132:135], v[168:171]
  ds_read_b64_tr_b16 v[116:117], v246 offset:0
  v_mfma_f32_16x16x32_bf16 v[172:175], v[108:111], v[132:135], v[172:175]
  ds_read_b64_tr_b16 v[118:119], v246 offset:1024
  v_mfma_f32_16x16x32_bf16 v[176:179], v[112:115], v[132:135], v[176:179]
  ds_read_b128 v[88:91], v244 offset:2048
  v_mfma_f32_16x16x32_bf16 v[180:183], v[100:103], v[136:139], v[180:183]
  ds_read_b128 v[92:95], v244 offset:4096
  v_mfma_f32_16x16x32_bf16 v[184:187], v[104:107], v[136:139], v[184:187]
  ds_read_b128 v[96:99], v244 offset:6144
  v_mfma_f32_16x16x32_bf16 v[188:191], v[108:111], v[136:139], v[188:191]
  ds_read_b64_tr_b16 v[120:121], v247 offset:0
  v_mfma_f32_16x16x32_bf16 v[192:195], v[112:115], v[136:139], v[192:195]
  ds_read_b64_tr_b16 v[122:123], v247 offset:1024
  v_mfma_f32_16x16x32_bf16 v[196:199], v[100:103], v[140:143], v[196:199]
  ds_read_b64_tr_b16 v[124:125], v248 offset:0
  v_mfma_f32_16x16x32_bf16 v[200:203], v[104:107], v[140:143], v[200:203]
  ds_read_b64_tr_b16 v[126:127], v248 offset:1024
  v_mfma_f32_16x16x32_bf16 v[204:207], v[108:111], v[140:143], v[204:207]
  ds_read_b64_tr_b16 v[128:129], v249 offset:0
  v_mfma_f32_16x16x32_bf16 v[208:211], v[112:115], v[140:143], v[208:211]
  ds_read_b64_tr_b16 v[130:131], v249 offset:1024
  v_mfma_f32_16x16x32_bf16 v[212:215], v[100:103], v[144:147], v[212:215]
  v_mfma_f32_16x16x32_bf16 v[216:219], v[104:107], v[144:147], v[216:219]
  v_mfma_f32_16x16x32_bf16 v[220:223], v[108:111], v[144:147], v[220:223]
  v_mfma_f32_16x16x32_bf16 v[224:227], v[112:115], v[144:147], v[224:227]
  s_cmp_lg_u32 s59, 0
  s_cbranch_scc1 L_loopv
L_epi1:
  s_waitcnt lgkmcnt(0)
  v_pk_mul_f32 v[164:165], v[164:165], s[56:57]
  v_pk_mul_f32 v[166:167], v[166:167], s[56:57]
  v_pk_mul_f32 v[168:169], v[168:169], s[56:57]
  v_pk_mul_f32 v[170:171], v[170:171], s[56:57]
  v_cvt_pk_bf16_f32 v116, v164, v165
  v_cvt_pk_bf16_f32 v117, v166, v167
  v_cvt_pk_bf16_f32 v118, v168, v169
  v_cvt_pk_bf16_f32 v119, v170, v171
  v_pk_mul_f32 v[172:173], v[172:173], s[56:57]
  v_pk_mul_f32 v[174:175], v[174:175], s[56:57]
  v_pk_mul_f32 v[176:177], v[176:177], s[56:57]
  v_pk_mul_f32 v[178:179], v[178:179], s[56:57]
  v_cvt_pk_bf16_f32 v120, v172, v173
  v_cvt_pk_bf16_f32 v121, v174, v175
  v_cvt_pk_bf16_f32 v122, v176, v177
  v_cvt_pk_bf16_f32 v123, v178, v179
  v_pk_mul_f32 v[180:181], v[180:181], s[56:57]
  v_pk_mul_f32 v[182:183], v[182:183], s[56:57]
  v_pk_mul_f32 v[184:185], v[184:185], s[56:57]
  v_pk_mul_f32 v[186:187], v[186:187], s[56:57]
  v_cvt_pk_bf16_f32 v124, v180, v181
  v_cvt_pk_bf16_f32 v125, v182, v183
  v_cvt_pk_bf16_f32 v126, v184, v185
  v_cvt_pk_bf16_f32 v127, v186, v187
  v_pk_mul_f32 v[188:189], v[188:189], s[56:57]
  v_pk_mul_f32 v[190:191], v[190:191], s[56:57]
  v_pk_mul_f32 v[192:193], v[192:193], s[56:57]
  v_pk_mul_f32 v[194:195], v[194:195], s[56:57]
  v_cvt_pk_bf16_f32 v128, v188, v189
  v_cvt_pk_bf16_f32 v129, v190, v191
  v_cvt_pk_bf16_f32 v130, v192, v193
  v_cvt_pk_bf16_f32 v131, v194, v195
  v_pk_mul_f32 v[196:197], v[196:197], s[56:57]
  v_pk_mul_f32 v[198:199], v[198:199], s[56:57]
  v_pk_mul_f32 v[200:201], v[200:201], s[56:57]
  v_pk_mul_f32 v[202:203], v[202:203], s[56:57]
  v_cvt_pk_bf16_f32 v132, v196, v197
  v_cvt_pk_bf16_f32 v133, v198, v199
  v_cvt_pk_bf16_f32 v134, v200, v201
  v_cvt_pk_bf16_f32 v135, v202, v203
  v_pk_mul_f32 v[204:205], v[204:205], s[56:57]
  v_pk_mul_f32 v[206:207], v[206:207], s[56:57]
  v_pk_mul_f32 v[208:209], v[208:209], s[56:57]
  v_pk_mul_f32 v[210:211], v[210:211], s[56:57]
  v_cvt_pk_bf16_f32 v136, v204, v205
  v_cvt_pk_bf16_f32 v137, v206, v207
  v_cvt_pk_bf16_f32 v138, v208, v209
  v_cvt_pk_bf16_f32 v139, v210, v211
  v_pk_mul_f32 v[212:213], v[212:213], s[56:57]
  v_pk_mul_f32 v[214:215], v[214:215], s[56:57]
  v_pk_mul_f32 v[216:217], v[216:217], s[56:57]
  v_pk_mul_f32 v[218:219], v[218:219], s[56:57]
  v_cvt_pk_bf16_f32 v140, v212, v213
  v_cvt_pk_bf16_f32 v141, v214, v215
  v_cvt_pk_bf16_f32 v142, v216, v217
  v_cvt_pk_bf16_f32 v143, v218, v219
  v_pk_mul_f32 v[220:221], v[220:221], s[56:57]
  v_pk_mul_f32 v[222:223], v[222:223], s[56:57]
  v_pk_mul_f32 v[224:225], v[224:225], s[56:57]
  v_pk_mul_f32 v[226:227], v[226:227], s[56:57]
  v_cvt_pk_bf16_f32 v144, v220, v221
  v_cvt_pk_bf16_f32 v145, v222, v223
  v_cvt_pk_bf16_f32 v146, v224, v225
  v_cvt_pk_bf16_f32 v147, v226, v227
  s_mul_i32 s52, s48, 20
  v_and_b32 v239, 1, v0
  v_mul_u32_u24 v239, 19, v239
  v_add_u32 v239, s52, v239
  v_lshrrev_b32 v239, 7, v239
  v_lshrrev_b32 v240, 1, v0
  v_mad_u32_u24 v239, v240, 5, v239
  v_lshlrev_b32 v239, 11, v239
  s_and_b32 s54, s2, 7
  s_lshl_b32 s54, s54, 8
  s_add_u32 s4, s54, 0x12c0000
  v_mov_b32 v236, 163824
  v_mov_b32 v237, 1
  v_lshlrev_b32 v240, 8, v0
  v_mov_b32 v241, 1
  s_barrier
  buffer_load_dword v255, off, s[36:39], 0 sc1
  buffer_store_dwordx4 v[116:119], v228, s[24:27], s96 offen sc1
  buffer_store_dwordx4 v[120:123], v229, s[24:27], s96 offen sc1
  buffer_store_dwordx4 v[124:127], v228, s[24:27], s97 offen sc1
  buffer_store_dwordx4 v[128:131], v229, s[24:27], s97 offen sc1
  buffer_store_dwordx4 v[132:135], v228, s[24:27], s98 offen sc1
  buffer_store_dwordx4 v[136:139], v229, s[24:27], s98 offen sc1
  buffer_store_dwordx4 v[140:143], v228, s[24:27], s99 offen sc1
  buffer_store_dwordx4 v[144:147], v229, s[24:27], s99 offen sc1
  s_mov_b32 m0, s9
  s_nop 0
  buffer_load_dwordx4 v231, s[32:35], s5 offen lds
  s_add_u32 m0, m0, s8
  s_nop 0
  buffer_load_dwordx4 v232, s[32:35], s5 offen lds
  s_add_u32 m0, m0, s8
  s_nop 0
  buffer_load_dwordx4 v233, s[32:35], s5 offen lds
  s_add_u32 m0, m0, s8
  s_nop 0
  buffer_load_dwordx4 v234, s[32:35], s5 offen lds
  s_add_u32 m0, m0, s8
  s_nop 0
  buffer_load_dwordx4 v235, s[32:35], s5 offen lds
  s_setprio 0
  s_waitcnt vmcnt(5)
  s_mov_b64 exec, 1
  ds_add_rtn_u32 v238, v236, v237
  s_mov_b64 exec, -1
  s_mov_b32 s53, 0
  s_waitcnt lgkmcnt(0)
  v_readfirstlane_b32 s52, v238
  v_readfirstlane_b32 s54, v255
  s_cmp_lg_u32 s52, 3
  s_cbranch_scc1 L_sigd
  s_cmp_eq_u32 s54, 0
  s_cbranch_scc1 L_rdy_spin
L_rdy:
  s_mov_b64 exec, 0xff
  buffer_atomic_add v241, v240, s[24:27], s10 offen sc1
  s_mov_b64 exec, 1
  ds_add_u32 v236, v237
  s_mov_b64 exec, -1
L_sigd:
L_lwsp0:
  ds_read_b32 v238, v236 offset:0
  s_waitcnt lgkmcnt(0)
  v_readfirstlane_b32 s52, v238
  s_cmp_lg_u32 s52, 5
  s_cbranch_scc1 L_lwsp0
  buffer_load_dwordx4 v[148:151], v158, s[28:31], s11 offen
  buffer_load_dwordx4 v[152:155], v158, s[28:31], s11 offen offset:512
  buffer_load_dwordx2 v[156:157], v159, s[28:31], s11 offen offset:1024
  buffer_load_dwordx4 v[164:167], v160, s[40:43], 0 offen
  buffer_load_dwordx4 v[168:171], v160, s[40:43], 0 offen offset:512
  buffer_load_dwordx2 v[172:173], v161, s[40:43], 0 offen offset:1024
L_lwsp:
  ds_read_b32 v238, v236 offset:12
  s_waitcnt lgkmcnt(0)
  v_readfirstlane_b32 s52, v238
  s_cmp_lg_u32 s52, 4
  s_cbranch_scc1 L_lwsp
  s_cmp_lg_u32 s44, 0
  s_cbranch_scc1 L_a_ok
  s_mov_b32 s53, 0
  s_mov_b64 exec, 0x3f
L_a_spin:
  buffer_load_dword v240, v239, s[24:27], s4 offen sc1
  s_waitcnt vmcnt(0)
  v_cmp_gt_u32 vcc, 16, v240
  s_add_u32 s53, s53, 1
  s_cbranch_vccz L_a_out
  s_cmp_le_u32 s53, 30000
  s_cbranch_scc1 L_a_spin
L_a_out:
  s_mov_b64 exec, -1
L_a_ok:
  s_lshl_b32 s52, s49, 3
  s_lshl_b32 s53, s44, 1
  s_add_u32 s52, s52, s53
  s_mul_i32 s52, s52, 40960
  s_mul_i32 s53, s48, 1280
  s_add_u32 s52, s52, s53
  s_mul_i32 s53, s44, 2560
  s_add_u32 m0, s53, 153600
  v_cmp_gt_u32 vcc, 16, v0
  v_add_u32 v236, 40704, v1
  v_add_u32 v237, 1024, v1
  v_add_u32 v238, 1024, v236
  v_cndmask_b32 v236, v236, v237, vcc
  s_barrier
  buffer_load_dwordx4 v1, s[24:27], s52 offen sc1 lds
  s_add_u32 m0, m0, 1024
  s_mul_i32 s53, s44, 81920
  buffer_load_dwordx4 v236, s[24:27], s52 offen sc1 lds
  s_add_u32 m0, m0, 1024
  s_mov_b64 exec, s[62:63]
  buffer_load_dwordx4 v238, s[24:27], s52 offen sc1 lds
  s_mov_b64 exec, -1
  s_mul_i32 m0, s44, 5120
  s_nop 0
  buffer_load_dwordx4 v250, s[24:27], s53 offen sc1 lds
  s_add_u32 m0, m0, 1024
  s_nop 0
  buffer_load_dwordx4 v251, s[24:27], s53 offen sc1 lds
  s_add_u32 m0, m0, 1024
  s_nop 0
  buffer_load_dwordx4 v252, s[24:27], s53 offen sc1 lds
  s_add_u32 m0, m0, 1024
  s_nop 0
  buffer_load_dwordx4 v253, s[24:27], s53 offen sc1 lds
  s_add_u32 m0, m0, 1024
  s_nop 0
  buffer_load_dwordx4 v254, s[24:27], s53 offen sc1 lds
  s_add_u32 m0, m0, 1024
  s_add_u32 s53, s53, 327680
  s_add_u32 m0, m0, 15360
  s_nop 0
  buffer_load_dwordx4 v250, s[24:27], s53 offen sc1 lds
  s_add_u32 m0, m0, 1024
  s_nop 0
  buffer_load_dwordx4 v251, s[24:27], s53 offen sc1 lds
  s_add_u32 m0, m0, 1024
  s_nop 0
  buffer_load_dwordx4 v252, s[24:27], s53 offen sc1 lds
  s_add_u32 m0, m0, 1024
  s_nop 0
  buffer_load_dwordx4 v253, s[24:27], s53 offen sc1 lds
  s_add_u32 m0, m0, 1024
  s_nop 0
  buffer_load_dwordx4 v254, s[24:27], s53 offen sc1 lds
  s_add_u32 m0, m0, 1024
  v_mov_b32 v108, 0
  v_mov_b32 v109, 0
  s_waitcnt vmcnt(13)
  ds_read_b64_tr_b16 v[88:89], v230 offset:0
  ds_read_b64_tr_b16 v[90:91], v230 offset:2560
  ds_read_b64_tr_b16 v[92:93], v230 offset:64
  ds_read_b64_tr_b16 v[94:95], v230 offset:2624
  ds_read_b64_tr_b16 v[96:97], v230 offset:128
  ds_read_b64_tr_b16 v[98:99], v230 offset:2688
  ds_read_b64_tr_b16 v[100:101], v230 offset:192
  ds_read_b64_tr_b16 v[102:103], v230 offset:2752
  ds_read_b64_tr_b16 v[104:105], v230 offset:256
  ds_read_b64_tr_b16 v[106:107], v230 offset:2816
  v_dot2c_f32_bf16 v108, v148, v164
  v_dot2c_f32_bf16 v109, v149, v165
  v_dot2c_f32_bf16 v108, v150, v166
  v_dot2c_f32_bf16 v109, v151, v167
  v_dot2c_f32_bf16 v108, v152, v168
  v_dot2c_f32_bf16 v109, v153, v169
  v_dot2c_f32_bf16 v108, v154, v170
  v_dot2c_f32_bf16 v109, v155, v171
  v_dot2c_f32_bf16 v108, v156, v172
  v_dot2c_f32_bf16 v109, v157, v173
  s_nop 2
  v_add_f32 v108, v108, v109
  s_nop 1
  v_add_f32_dpp v108, v108, v108 row_shr:1 row_mask:0xf bank_mask:0xf
  s_nop 1
  v_add_f32_dpp v108, v108, v108 row_shr:2 row_mask:0xf bank_mask:0xf
  s_nop 1
  v_add_f32_dpp v108, v108, v108 row_shr:4 row_mask:0xf bank_mask:0xf
  s_nop 1
  v_add_f32_dpp v108, v108, v108 row_shr:8 row_mask:0xf bank_mask:0xf
  s_nop 1
  v_add_f32_dpp v108, v108, v108 row_bcast:15 row_mask:0xa bank_mask:0xf
  v_mul_f32 v108, 0xbfb8aa3b, v108
  v_exp_f32 v108, v108
  v_mov_b32 v248, v1
  v_add_f32 v108, 1.0, v108
  v_rcp_f32 v108, v108
  v_mov_b32 v249, v162
  s_mov_b32 s6, s100
  s_mov_b32 s7, 139264
  s_mov_b32 s8, 139264
  s_mov_b32 s9, s101
  s_mov_b32 s12, 0x80000000
  s_mov_b32 s13, 0x80000000
  s_waitcnt vmcnt(5) lgkmcnt(0)
L_att:
  s_lshl_b32 s56, s49, 3
  s_add_u32 s56, s56, s44
  s_add_u32 s57, s44, 8
  s_mul_i32 m0, s57, 5120
  s_mul_i32 s57, s57, 81920
  s_barrier
  ds_read2st64_b64 v[72:75], v7 offset0:0 offset1:1
  ds_read2st64_b64 v[76:79], v2 offset0:0 offset1:1
  s_mov_b64 exec, s[62:63]
  ds_read_b64 v[80:81], v7 offset:1024
  ds_read_b64 v[82:83], v2 offset:1024
  s_mov_b64 exec, s[60:61]
  ds_read_b128 v[56:59], v3 offset:0
  ds_read_b128 v[60:63], v3 offset:640
  s_mov_b64 exec, -1
  s_waitcnt lgkmcnt(2)
  v_mfma_f32_32x32x16_bf16 v[8:23], v[76:79], v[72:75], 0
  v_mfma_f32_32x32x8_bf16 v[8:23], v[82:83], v[80:81], v[8:23]
  buffer_load_dwordx4 v250, s[24:27], s57 offen sc1 lds
  s_add_u32 m0, m0, 1024
  s_nop 0
  buffer_load_dwordx4 v251, s[24:27], s57 offen sc1 lds
  s_add_u32 m0, m0, 1024
  s_nop 0
  buffer_load_dwordx4 v252, s[24:27], s57 offen sc1 lds
  s_add_u32 m0, m0, 1024
  s_nop 0
  buffer_load_dwordx4 v253, s[24:27], s57 offen sc1 lds
  s_add_u32 m0, m0, 1024
  s_nop 0
  buffer_load_dwordx4 v254, s[24:27], s57 offen sc1 lds
  s_add_u32 m0, m0, 1024
  s_nop 0
  s_add_u32 s57, s57, 655360
  s_add_u32 m0, m0, 35840
  v_max3_f32 v84, v8, v9, v10
  v_max3_f32 v85, v11, v12, v13
  v_max3_f32 v84, v84, v14, v15
  v_max3_f32 v85, v85, v16, v17
  v_max3_f32 v84, v84, v18, v19
  v_max3_f32 v85, v85, v20, v21
  v_max3_f32 v84, v84, v22, v23
  v_max_f32 v84, v84, v85
  v_mov_b32 v85, v84
  s_not_b64 s[52:53], s[62:63]
  s_nop 0
  v_permlane32_swap_b32 v84, v85
  s_nop 0
  v_max_f32 v84, v84, v85
  s_mov_b64 exec, s[52:53]
  v_cvt_pk_bf16_f32 v80, -v84, 0
  s_mov_b64 exec, -1
  v_mfma_f32_32x32x16_bf16 v[8:23], v[76:79], v[72:75], 0
  s_nop 0
  v_mfma_f32_32x32x8_bf16 v[8:23], v[82:83], v[80:81], v[8:23]
  ds_read2st64_b64 v[76:79], v2 offset0:5 offset1:6
  s_mov_b64 exec, s[62:63]
  ds_read_b64 v[82:83], v2 offset:3584
  s_mov_b64 exec, -1
  s_min_u32 s52, s44, 4
  s_mul_i32 s53, s51, 5
  s_add_u32 s52, s52, s53
  s_mul_i32 s54, s52, 139264
  s_add_u32 s54, s54, 0x1010000
  s_add_u32 s100, s54, 98304
  s_sub_u32 s52, s44, 4
  s_cmp_ge_u32 s44, 4
  s_cselect_b32 s52, s52, 0
  s_lshl_b32 s53, s52, 1
  s_add_u32 s53, s53, s50
  s_and_b32 s53, s53, 7
  s_sub_u32 s96, 8, s53
  s_mul_i32 s55, s53, 12288
  s_add_u32 s58, s54, s55
  s_mov_b32 s101, -94208
  s_lshl_b32 s53, s52, 13
  s_add_u32 s97, s100, s53
  s_lshl_b32 s53, s52, 11
  s_add_u32 s98, s100, s53
  s_add_u32 s98, s98, 32768
  s_cmp_ge_u32 s44, 4
  s_mul_i32 s53, s51, 5
  s_add_u32 s53, s53, s52
  s_mul_i32 s53, s53, 139264
  s_add_u32 s55, s50, 7
  s_and_b32 s55, s55, 7
  s_mul_i32 s55, s55, 12288
  s_add_u32 s53, s53, s55
  s_add_u32 s99, s53, 0x100f800
  s_setprio 1
  v_exp_f32 v8, v8
  v_exp_f32 v9, v9
  v_smfmac_f32_32x32x32_bf16 v[40:55], v[68:71], v[32:39], v4
  v_exp_f32 v10, v10
  s_mov_b64 exec, s[60:61]
  ds_read_b128 v[64:67], v3 offset:2560
  ds_read_b128 v[68:71], v3 offset:3200
  s_mov_b64 exec, -1
  v_exp_f32 v11, v11
  v_exp_f32 v12, v12
  v_exp_f32 v13, v13
  s_waitcnt lgkmcnt(2)
  v_mfma_f32_32x32x16_bf16 v[24:39], v[76:79], v[72:75], 0
  v_exp_f32 v14, v14
  v_exp_f32 v15, v15
  v_exp_f32 v16, v16
  v_exp_f32 v17, v17
  v_mfma_f32_32x32x8_bf16 v[24:39], v[82:83], v[80:81], v[24:39]
  s_setprio 0
  ds_read2st64_b64 v[76:79], v2 offset0:10 offset1:11
  v_exp_f32 v18, v18
  s_mov_b64 exec, s[62:63]
  ds_read_b64 v[82:83], v2 offset:6144
  s_mov_b64 exec, -1
  v_exp_f32 v19, v19
  v_exp_f32 v20, v20
  v_exp_f32 v21, v21
  s_waitcnt lgkmcnt(4)
  v_smfmac_f32_32x32x32_bf16 v[40:55], v[56:59], v[8:15], v4
  v_exp_f32 v22, v22
  v_exp_f32 v23, v23
  buffer_store_dwordx4 v[88:91], v248, s[24:27], s6 offen sc1
  s_add_u32 s6, s6, s7
  s_setprio 1
  v_exp_f32 v24, v24
  v_exp_f32 v25, v25
  v_smfmac_f32_32x32x32_bf16 v[40:55], v[60:63], v[16:23], v4
  v_exp_f32 v26, v26
  s_mov_b64 exec, s[60:61]
  ds_read_b128 v[56:59], v3 offset:5120
  ds_read_b128 v[60:63], v3 offset:5760
  s_mov_b64 exec, -1
  v_exp_f32 v27, v27
  v_exp_f32 v28, v28
  v_exp_f32 v29, v29
  s_waitcnt lgkmcnt(2)
  v_mfma_f32_32x32x16_bf16 v[8:23], v[76:79], v[72:75], 0
  v_exp_f32 v30, v30
  v_exp_f32 v31, v31
  v_exp_f32 v32, v32
  v_exp_f32 v33, v33
  v_mfma_f32_32x32x8_bf16 v[8:23], v[82:83], v[80:81], v[8:23]
  s_setprio 0
  ds_read2st64_b64 v[76:79], v2 offset0:15 offset1:16
  v_exp_f32 v34, v34
  s_mov_b64 exec, s[62:63]
  ds_read_b64 v[82:83], v2 offset:8704
  s_mov_b64 exec, -1
  v_exp_f32 v35, v35
  v_exp_f32 v36, v36
  v_exp_f32 v37, v37
  s_waitcnt lgkmcnt(4)
  v_smfmac_f32_32x32x32_bf16 v[40:55], v[64:67], v[24:31], v4
  v_exp_f32 v38, v38
  v_exp_f32 v39, v39
  buffer_store_dwordx4 v[92:95], v248, s[24:27], s6 offen sc1
  s_add_u32 s6, s6, s8
  s_setprio 1
  v_exp_f32 v8, v8
  v_exp_f32 v9, v9
  v_smfmac_f32_32x32x32_bf16 v[40:55], v[68:71], v[32:39], v4
  v_exp_f32 v10, v10
  s_mov_b64 exec, s[60:61]
  ds_read_b128 v[64:67], v3 offset:7680
  ds_read_b128 v[68:71], v3 offset:8320
  s_mov_b64 exec, -1
  v_exp_f32 v11, v11
  v_exp_f32 v12, v12
  v_exp_f32 v13, v13
  s_waitcnt lgkmcnt(2)
  v_mfma_f32_32x32x16_bf16 v[24:39], v[76:79], v[72:75], 0
  v_exp_f32 v14, v14
  v_exp_f32 v15, v15
  v_exp_f32 v16, v16
  v_exp_f32 v17, v17
  v_mfma_f32_32x32x8_bf16 v[24:39], v[82:83], v[80:81], v[24:39]
  s_setprio 0
  ds_read2st64_b64 v[76:79], v2 offset0:20 offset1:21
  v_exp_f32 v18, v18
  s_mov_b64 exec, s[62:63]
  ds_read_b64 v[82:83], v2 offset:11264
  s_mov_b64 exec, -1
  v_exp_f32 v19, v19
  v_exp_f32 v20, v20
  v_exp_f32 v21, v21
  s_waitcnt lgkmcnt(4)
  v_smfmac_f32_32x32x32_bf16 v[40:55], v[56:59], v[8:15], v4
  v_exp_f32 v22, v22
  v_exp_f32 v23, v23
  buffer_store_dwordx4 v[96:99], v248, s[24:27], s6 offen sc1
  s_add_u32 s6, s6, s7
  s_setprio 1
  v_exp_f32 v24, v24
  v_exp_f32 v25, v25
  v_smfmac_f32_32x32x32_bf16 v[40:55], v[60:63], v[16:23], v4
  v_exp_f32 v26, v26
  s_mov_b64 exec, s[60:61]
  ds_read_b128 v[56:59], v3 offset:10240
  ds_read_b128 v[60:63], v3 offset:10880
  s_mov_b64 exec, -1
  v_exp_f32 v27, v27
  v_exp_f32 v28, v28
  v_exp_f32 v29, v29
  s_waitcnt lgkmcnt(2)
  v_mfma_f32_32x32x16_bf16 v[8:23], v[76:79], v[72:75], 0
  v_exp_f32 v30, v30
  v_exp_f32 v31, v31
  v_exp_f32 v32, v32
  v_exp_f32 v33, v33
  v_mfma_f32_32x32x8_bf16 v[8:23], v[82:83], v[80:81], v[8:23]
  s_setprio 0
  ds_read2st64_b64 v[76:79], v2 offset0:25 offset1:26
  v_exp_f32 v34, v34
  s_mov_b64 exec, s[62:63]
  ds_read_b64 v[82:83], v2 offset:13824
  s_mov_b64 exec, -1
  v_exp_f32 v35, v35
  v_exp_f32 v36, v36
  v_exp_f32 v37, v37
  s_waitcnt lgkmcnt(4)
  v_smfmac_f32_32x32x32_bf16 v[40:55], v[64:67], v[24:31], v4
  v_exp_f32 v38, v38
  v_exp_f32 v39, v39
  buffer_store_dwordx4 v[100:103], v248, s[24:27], s6 offen sc1
  s_add_u32 s6, s6, s8
  s_setprio 1
  v_exp_f32 v8, v8
  v_exp_f32 v9, v9
  v_smfmac_f32_32x32x32_bf16 v[40:55], v[68:71], v[32:39], v4
  v_exp_f32 v10, v10
  s_mov_b64 exec, s[60:61]
  ds_read_b128 v[64:67], v3 offset:12800
  ds_read_b128 v[68:71], v3 offset:13440
  s_mov_b64 exec, -1
  v_exp_f32 v11, v11
  v_exp_f32 v12, v12
  v_exp_f32 v13, v13
  s_waitcnt lgkmcnt(2)
  v_mfma_f32_32x32x16_bf16 v[24:39], v[76:79], v[72:75], 0
  v_exp_f32 v14, v14
  v_exp_f32 v15, v15
  v_exp_f32 v16, v16
  v_exp_f32 v17, v17
  v_mfma_f32_32x32x8_bf16 v[24:39], v[82:83], v[80:81], v[24:39]
  s_setprio 0
  ds_read2st64_b64 v[76:79], v2 offset0:30 offset1:31
  v_exp_f32 v18, v18
  s_mov_b64 exec, s[62:63]
  ds_read_b64 v[82:83], v2 offset:16384
  s_mov_b64 exec, -1
  v_exp_f32 v19, v19
  v_exp_f32 v20, v20
  v_exp_f32 v21, v21
  s_waitcnt lgkmcnt(4)
  v_smfmac_f32_32x32x32_bf16 v[40:55], v[56:59], v[8:15], v4
  v_exp_f32 v22, v22
  v_exp_f32 v23, v23
  buffer_store_dwordx4 v[104:107], v248, s[24:27], s6 offen sc1
  s_add_u32 s6, s6, s7
  s_setprio 1
  v_exp_f32 v24, v24
  v_exp_f32 v25, v25
  v_smfmac_f32_32x32x32_bf16 v[40:55], v[60:63], v[16:23], v4
  v_exp_f32 v26, v26
  s_mov_b64 exec, s[60:61]
  ds_read_b128 v[56:59], v3 offset:15360
  ds_read_b128 v[60:63], v3 offset:16000
  s_mov_b64 exec, -1
  v_exp_f32 v27, v27
  v_exp_f32 v28, v28
  v_exp_f32 v29, v29
  s_waitcnt lgkmcnt(2)
  v_mfma_f32_32x32x16_bf16 v[8:23], v[76:79], v[72:75], 0
  v_exp_f32 v30, v30
  v_exp_f32 v31, v31
  v_exp_f32 v32, v32
  v_exp_f32 v33, v33
  v_mfma_f32_32x32x8_bf16 v[8:23], v[82:83], v[80:81], v[8:23]
  s_setprio 0
  ds_read2st64_b64 v[76:79], v2 offset0:35 offset1:36
  v_exp_f32 v34, v34
  s_mov_b64 exec, s[62:63]
  ds_read_b64 v[82:83], v2 offset:18944
  s_mov_b64 exec, -1
  v_exp_f32 v35, v35
  v_exp_f32 v36, v36
  v_exp_f32 v37, v37
  s_waitcnt lgkmcnt(4)
  v_smfmac_f32_32x32x32_bf16 v[40:55], v[64:67], v[24:31], v4
  v_exp_f32 v38, v38
  v_exp_f32 v39, v39
  s_mov_b64 exec, s[12:13]
  buffer_store_dwordx4 v[108:111], v249, s[24:27], s9 offen sc1
  s_mov_b64 exec, -1
  s_waitcnt vmcnt(11)
  s_barrier
  s_setprio 1
  v_exp_f32 v8, v8
  v_exp_f32 v9, v9
  v_smfmac_f32_32x32x32_bf16 v[40:55], v[68:71], v[32:39], v4
  v_exp_f32 v10, v10
  s_mov_b64 exec, s[60:61]
  ds_read_b128 v[64:67], v3 offset:17920
  ds_read_b128 v[68:71], v3 offset:18560
  s_mov_b64 exec, -1
  v_exp_f32 v11, v11
  v_exp_f32 v12, v12
  v_exp_f32 v13, v13
  s_waitcnt lgkmcnt(2)
  v_mfma_f32_32x32x16_bf16 v[24:39], v[76:79], v[72:75], 0
  v_exp_f32 v14, v14
  v_exp_f32 v15, v15
  v_exp_f32 v16, v16
  v_exp_f32 v17, v17
  v_mfma_f32_32x32x8_bf16 v[24:39], v[82:83], v[80:81], v[24:39]
  s_setprio 0
  ds_read2st64_b64 v[76:79], v2 offset0:40 offset1:41
  v_exp_f32 v18, v18
  s_mov_b64 exec, s[62:63]
  ds_read_b64 v[82:83], v2 offset:21504
  s_mov_b64 exec, -1
  v_exp_f32 v19, v19
  v_exp_f32 v20, v20
  v_exp_f32 v21, v21
  s_waitcnt lgkmcnt(4)
  v_smfmac_f32_32x32x32_bf16 v[40:55], v[56:59], v[8:15], v4
  v_exp_f32 v22, v22
  v_exp_f32 v23, v23
  buffer_load_dwordx4 v250, s[24:27], s57 offen sc1 lds
  s_add_u32 m0, m0, 1024
  s_setprio 1
  v_exp_f32 v24, v24
  v_exp_f32 v25, v25
  v_smfmac_f32_32x32x32_bf16 v[40:55], v[60:63], v[16:23], v4
  v_exp_f32 v26, v26
  s_mov_b64 exec, s[60:61]
  ds_read_b128 v[56:59], v3 offset:20480
  ds_read_b128 v[60:63], v3 offset:21120
  s_mov_b64 exec, -1
  v_exp_f32 v27, v27
  v_exp_f32 v28, v28
  v_exp_f32 v29, v29
  s_waitcnt lgkmcnt(2)
  v_mfma_f32_32x32x16_bf16 v[8:23], v[76:79], v[72:75], 0
  v_exp_f32 v30, v30
  v_exp_f32 v31, v31
  v_exp_f32 v32, v32
  v_exp_f32 v33, v33
  v_mfma_f32_32x32x8_bf16 v[8:23], v[82:83], v[80:81], v[8:23]
  s_setprio 0
  ds_read2st64_b64 v[76:79], v2 offset0:45 offset1:46
  v_exp_f32 v34, v34
  s_mov_b64 exec, s[62:63]
  ds_read_b64 v[82:83], v2 offset:24064
  s_mov_b64 exec, -1
  v_exp_f32 v35, v35
  v_exp_f32 v36, v36
  v_exp_f32 v37, v37
  s_waitcnt lgkmcnt(4)
  v_smfmac_f32_32x32x32_bf16 v[40:55], v[64:67], v[24:31], v4
  v_exp_f32 v38, v38
  v_exp_f32 v39, v39
  buffer_load_dwordx4 v251, s[24:27], s57 offen sc1 lds
  s_add_u32 m0, m0, 1024
  s_setprio 1
  v_exp_f32 v8, v8
  v_exp_f32 v9, v9
  v_smfmac_f32_32x32x32_bf16 v[40:55], v[68:71], v[32:39], v4
  v_exp_f32 v10, v10
  s_mov_b64 exec, s[60:61]
  ds_read_b128 v[64:67], v3 offset:23040
  ds_read_b128 v[68:71], v3 offset:23680
  s_mov_b64 exec, -1
  v_exp_f32 v11, v11
  v_exp_f32 v12, v12
  v_exp_f32 v13, v13
  s_waitcnt lgkmcnt(2)
  v_mfma_f32_32x32x16_bf16 v[24:39], v[76:79], v[72:75], 0
  v_exp_f32 v14, v14
  v_exp_f32 v15, v15
  v_exp_f32 v16, v16
  v_exp_f32 v17, v17
  v_mfma_f32_32x32x8_bf16 v[24:39], v[82:83], v[80:81], v[24:39]
  s_setprio 0
  ds_read2st64_b64 v[76:79], v2 offset0:50 offset1:51
  v_exp_f32 v18, v18
  s_mov_b64 exec, s[62:63]
  ds_read_b64 v[82:83], v2 offset:26624
  s_mov_b64 exec, -1
  v_exp_f32 v19, v19
  v_exp_f32 v20, v20
  v_exp_f32 v21, v21
  s_waitcnt lgkmcnt(4)
  v_smfmac_f32_32x32x32_bf16 v[40:55], v[56:59], v[8:15], v4
  v_exp_f32 v22, v22
  v_exp_f32 v23, v23
  buffer_load_dwordx4 v252, s[24:27], s57 offen sc1 lds
  s_add_u32 m0, m0, 1024
  s_setprio 1
  v_exp_f32 v24, v24
  v_exp_f32 v25, v25
  v_smfmac_f32_32x32x32_bf16 v[40:55], v[60:63], v[16:23], v4
  v_exp_f32 v26, v26
  s_mov_b64 exec, s[60:61]
  ds_read_b128 v[56:59], v3 offset:25600
  ds_read_b128 v[60:63], v3 offset:26240
  s_mov_b64 exec, -1
  v_exp_f32 v27, v27
  v_exp_f32 v28, v28
  v_exp_f32 v29, v29
  s_waitcnt lgkmcnt(2)
  v_mfma_f32_32x32x16_bf16 v[8:23], v[76:79], v[72:75], 0
  v_exp_f32 v30, v30
  v_exp_f32 v31, v31
  v_exp_f32 v32, v32
  v_exp_f32 v33, v33
  v_mfma_f32_32x32x8_bf16 v[8:23], v[82:83], v[80:81], v[8:23]
  s_setprio 0
  ds_read2st64_b64 v[76:79], v2 offset0:55 offset1:56
  v_exp_f32 v34, v34
  s_mov_b64 exec, s[62:63]
  ds_read_b64 v[82:83], v2 offset:29184
  s_mov_b64 exec, -1
  v_exp_f32 v35, v35
  v_exp_f32 v36, v36
  v_exp_f32 v37, v37
  s_waitcnt lgkmcnt(4)
  v_smfmac_f32_32x32x32_bf16 v[40:55], v[64:67], v[24:31], v4
  v_exp_f32 v38, v38
  v_exp_f32 v39, v39
  buffer_load_dwordx4 v253, s[24:27], s57 offen sc1 lds
  s_add_u32 m0, m0, 1024
  s_setprio 1
  v_exp_f32 v8, v8
  v_exp_f32 v9, v9
  v_smfmac_f32_32x32x32_bf16 v[40:55], v[68:71], v[32:39], v4
  v_exp_f32 v10, v10
  s_mov_b64 exec, s[60:61]
  ds_read_b128 v[64:67], v3 offset:28160
  ds_read_b128 v[68:71], v3 offset:28800
  s_mov_b64 exec, -1
  v_exp_f32 v11, v11
  v_exp_f32 v12, v12
  v_exp_f32 v13, v13
  s_waitcnt lgkmcnt(2)
  v_mfma_f32_32x32x16_bf16 v[24:39], v[76:79], v[72:75], 0
  v_exp_f32 v14, v14
  v_exp_f32 v15, v15
  v_exp_f32 v16, v16
  v_exp_f32 v17, v17
  v_mfma_f32_32x32x8_bf16 v[24:39], v[82:83], v[80:81], v[24:39]
  s_setprio 0
  ds_read2st64_b64 v[76:79], v2 offset0:60 offset1:61
  v_exp_f32 v18, v18
  s_mov_b64 exec, s[62:63]
  ds_read_b64 v[82:83], v2 offset:31744
  s_mov_b64 exec, -1
  v_exp_f32 v19, v19
  v_exp_f32 v20, v20
  v_exp_f32 v21, v21
  s_waitcnt lgkmcnt(4)
  v_smfmac_f32_32x32x32_bf16 v[40:55], v[56:59], v[8:15], v4
  v_exp_f32 v22, v22
  v_exp_f32 v23, v23
  buffer_load_dwordx4 v254, s[24:27], s57 offen sc1 lds
  s_add_u32 m0, m0, 1024
  s_add_u32 s57, s57, 655360
  s_add_u32 m0, m0, 35840
  s_setprio 1
  v_exp_f32 v24, v24
  v_exp_f32 v25, v25
  v_smfmac_f32_32x32x32_bf16 v[40:55], v[60:63], v[16:23], v4
  v_exp_f32 v26, v26
  s_mov_b64 exec, s[60:61]
  ds_read_b128 v[56:59], v3 offset:30720
  ds_read_b128 v[60:63], v3 offset:31360
  s_mov_b64 exec, -1
  v_exp_f32 v27, v27
  v_exp_f32 v28, v28
  v_exp_f32 v29, v29
  s_waitcnt lgkmcnt(2)
  v_mfma_f32_32x32x16_bf16 v[8:23], v[76:79], v[72:75], 0
  v_exp_f32 v30, v30
  v_exp_f32 v31, v31
  v_exp_f32 v32, v32
  v_exp_f32 v33, v33
  v_mfma_f32_32x32x8_bf16 v[8:23], v[82:83], v[80:81], v[8:23]
  s_setprio 0
  ds_read2st64_b64 v[76:79], v2 offset0:65 offset1:66
  v_exp_f32 v34, v34
  s_mov_b64 exec, s[62:63]
  ds_read_b64 v[82:83], v2 offset:34304
  s_mov_b64 exec, -1
  v_exp_f32 v35, v35
  v_exp_f32 v36, v36
  v_exp_f32 v37, v37
  s_waitcnt lgkmcnt(4)
  v_smfmac_f32_32x32x32_bf16 v[40:55], v[64:67], v[24:31], v4
  v_exp_f32 v38, v38
  v_exp_f32 v39, v39
  s_nop 0
  s_nop 0
  s_setprio 1
  v_exp_f32 v8, v8
  v_exp_f32 v9, v9
  v_smfmac_f32_32x32x32_bf16 v[40:55], v[68:71], v[32:39], v4
  v_exp_f32 v10, v10
  s_mov_b64 exec, s[60:61]
  ds_read_b128 v[64:67], v3 offset:33280
  ds_read_b128 v[68:71], v3 offset:33920
  s_mov_b64 exec, -1
  v_exp_f32 v11, v11
  v_exp_f32 v12, v12
  v_exp_f32 v13, v13
  s_waitcnt lgkmcnt(2)
  v_mfma_f32_32x32x16_bf16 v[24:39], v[76:79], v[72:75], 0
  v_exp_f32 v14, v14
  v_exp_f32 v15, v15
  v_exp_f32 v16, v16
  v_exp_f32 v17, v17
  v_mfma_f32_32x32x8_bf16 v[24:39], v[82:83], v[80:81], v[24:39]
  s_setprio 0
  ds_read2st64_b64 v[76:79], v2 offset0:70 offset1:71
  v_exp_f32 v18, v18
  s_mov_b64 exec, s[62:63]
  ds_read_b64 v[82:83], v2 offset:36864
  s_mov_b64 exec, -1
  v_exp_f32 v19, v19
  v_exp_f32 v20, v20
  v_exp_f32 v21, v21
  s_waitcnt lgkmcnt(4)
  v_smfmac_f32_32x32x32_bf16 v[40:55], v[56:59], v[8:15], v4
  v_exp_f32 v22, v22
  v_exp_f32 v23, v23
  s_waitcnt vmcnt(0)
  s_barrier
  s_lshl_b32 s52, s45, 11
  s_add_u32 s52, s52, 0x12c8000
  s_cmp_eq_u32 s44, 0
  s_cselect_b32 s52, s52, 0x10000000
  v_lshlrev_b32 v84, 8, v0
  v_mov_b32 v85, 1
  s_mov_b64 exec, 0xff
  buffer_atomic_add v85, v84, s[24:27], s52 offen sc1
  s_mov_b64 exec, -1
  s_setprio 1
  v_exp_f32 v24, v24
  v_exp_f32 v25, v25
  v_smfmac_f32_32x32x32_bf16 v[40:55], v[60:63], v[16:23], v4
  v_exp_f32 v26, v26
  s_mov_b64 exec, s[60:61]
  ds_read_b128 v[56:59], v3 offset:35840
  ds_read_b128 v[60:63], v3 offset:36480
  s_mov_b64 exec, -1
  v_exp_f32 v27, v27
  v_exp_f32 v28, v28
  v_exp_f32 v29, v29
  s_waitcnt lgkmcnt(2)
  v_mfma_f32_32x32x16_bf16 v[8:23], v[76:79], v[72:75], 0
  v_exp_f32 v30, v30
  v_exp_f32 v31, v31
  v_exp_f32 v32, v32
  v_exp_f32 v33, v33
  v_mfma_f32_32x32x8_bf16 v[8:23], v[82:83], v[80:81], v[8:23]
  s_setprio 0
  ds_read2st64_b64 v[76:79], v2 offset0:75 offset1:76
  v_exp_f32 v34, v34
  s_mov_b64 exec, s[62:63]
  ds_read_b64 v[82:83], v2 offset:39424
  s_mov_b64 exec, -1
  v_exp_f32 v35, v35
  v_exp_f32 v36, v36
  v_exp_f32 v37, v37
  s_waitcnt lgkmcnt(4)
  v_smfmac_f32_32x32x32_bf16 v[40:55], v[64:67], v[24:31], v4
  v_exp_f32 v38, v38
  v_exp_f32 v39, v39
  buffer_load_dwordx4 v250, s[24:27], s57 offen sc1 lds
  s_add_u32 m0, m0, 1024
  s_setprio 1
  v_exp_f32 v8, v8
  v_exp_f32 v9, v9
  v_smfmac_f32_32x32x32_bf16 v[40:55], v[68:71], v[32:39], v4
  v_exp_f32 v10, v10
  s_mov_b64 exec, s[60:61]
  ds_read_b128 v[64:67], v3 offset:38400
  ds_read_b128 v[68:71], v3 offset:39040
  s_mov_b64 exec, -1
  v_exp_f32 v11, v11
  v_exp_f32 v12, v12
  v_exp_f32 v13, v13
  s_waitcnt lgkmcnt(2)
  v_mfma_f32_32x32x16_bf16 v[24:39], v[76:79], v[72:75], 0
  v_exp_f32 v14, v14
  v_exp_f32 v15, v15
  v_exp_f32 v16, v16
  v_exp_f32 v17, v17
  v_mfma_f32_32x32x8_bf16 v[24:39], v[82:83], v[80:81], v[24:39]
  s_setprio 0
  ds_read2st64_b64 v[76:79], v2 offset0:80 offset1:81
  v_exp_f32 v18, v18
  s_mov_b64 exec, s[62:63]
  ds_read_b64 v[82:83], v2 offset:41984
  s_mov_b64 exec, -1
  v_exp_f32 v19, v19
  v_exp_f32 v20, v20
  v_exp_f32 v21, v21
  s_waitcnt lgkmcnt(4)
  v_smfmac_f32_32x32x32_bf16 v[40:55], v[56:59], v[8:15], v4
  v_exp_f32 v22, v22
  v_exp_f32 v23, v23
  buffer_load_dwordx4 v251, s[24:27], s57 offen sc1 lds
  s_add_u32 m0, m0, 1024
  s_setprio 1
  v_exp_f32 v24, v24
  v_exp_f32 v25, v25
  v_smfmac_f32_32x32x32_bf16 v[40:55], v[60:63], v[16:23], v4
  v_exp_f32 v26, v26
  s_mov_b64 exec, s[60:61]
  ds_read_b128 v[56:59], v3 offset:40960
  ds_read_b128 v[60:63], v3 offset:41600
  s_mov_b64 exec, -1
  v_exp_f32 v27, v27
  v_exp_f32 v28, v28
  v_exp_f32 v29, v29
  s_waitcnt lgkmcnt(2)
  v_mfma_f32_32x32x16_bf16 v[8:23], v[76:79], v[72:75], 0
  v_exp_f32 v30, v30
  v_exp_f32 v31, v31
  v_exp_f32 v32, v32
  v_exp_f32 v33, v33
  v_mfma_f32_32x32x8_bf16 v[8:23], v[82:83], v[80:81], v[8:23]
  s_setprio 0
  ds_read2st64_b64 v[76:79], v2 offset0:85 offset1:86
  v_exp_f32 v34, v34
  s_mov_b64 exec, s[62:63]
  ds_read_b64 v[82:83], v2 offset:44544
  s_mov_b64 exec, -1
  v_exp_f32 v35, v35
  v_exp_f32 v36, v36
  v_exp_f32 v37, v37
  s_waitcnt lgkmcnt(4)
  v_smfmac_f32_32x32x32_bf16 v[40:55], v[64:67], v[24:31], v4
  v_exp_f32 v38, v38
  v_exp_f32 v39, v39
  buffer_load_dwordx4 v252, s[24:27], s57 offen sc1 lds
  s_add_u32 m0, m0, 1024
  v_add_u32 v2, 40960, v2
  v_add_u32 v3, 40960, v3
  s_setprio 1
  v_exp_f32 v8, v8
  v_exp_f32 v9, v9
  v_smfmac_f32_32x32x32_bf16 v[40:55], v[68:71], v[32:39], v4
  v_exp_f32 v10, v10
  s_mov_b64 exec, s[60:61]
  ds_read_b128 v[64:67], v3 offset:2560
  ds_read_b128 v[68:71], v3 offset:3200
  s_mov_b64 exec, -1
  v_exp_f32 v11, v11
  v_exp_f32 v12, v12
  v_exp_f32 v13, v13
  s_waitcnt lgkmcnt(2)
  v_mfma_f32_32x32x16_bf16 v[24:39], v[76:79], v[72:75], 0
  v_exp_f32 v14, v14
  v_exp_f32 v15, v15
  v_exp_f32 v16, v16
  v_exp_f32 v17, v17
  v_mfma_f32_32x32x8_bf16 v[24:39], v[82:83], v[80:81], v[24:39]
  s_setprio 0
  ds_read2st64_b64 v[76:79], v2 offset0:10 offset1:11
  v_exp_f32 v18, v18
  s_mov_b64 exec, s[62:63]
  ds_read_b64 v[82:83], v2 offset:6144
  s_mov_b64 exec, -1
  v_exp_f32 v19, v19
  v_exp_f32 v20, v20
  v_exp_f32 v21, v21
  s_waitcnt lgkmcnt(4)
  v_smfmac_f32_32x32x32_bf16 v[40:55], v[56:59], v[8:15], v4
  v_exp_f32 v22, v22
  v_exp_f32 v23, v23
  buffer_load_dwordx4 v253, s[24:27], s57 offen sc1 lds
  s_add_u32 m0, m0, 1024
  s_setprio 1
  v_exp_f32 v24, v24
  v_exp_f32 v25, v25
  v_smfmac_f32_32x32x32_bf16 v[40:55], v[60:63], v[16:23], v4
  v_exp_f32 v26, v26
  s_mov_b64 exec, s[60:61]
  ds_read_b128 v[56:59], v3 offset:5120
  ds_read_b128 v[60:63], v3 offset:5760
  s_mov_b64 exec, -1
  v_exp_f32 v27, v27
  v_exp_f32 v28, v28
  v_exp_f32 v29, v29
  s_waitcnt lgkmcnt(2)
  v_mfma_f32_32x32x16_bf16 v[8:23], v[76:79], v[72:75], 0
  v_exp_f32 v30, v30
  v_exp_f32 v31, v31
  v_exp_f32 v32, v32
  v_exp_f32 v33, v33
  v_mfma_f32_32x32x8_bf16 v[8:23], v[82:83], v[80:81], v[8:23]
  s_setprio 0
  ds_read2st64_b64 v[76:79], v2 offset0:15 offset1:16
  v_exp_f32 v34, v34
  s_mov_b64 exec, s[62:63]
  ds_read_b64 v[82:83], v2 offset:8704
  s_mov_b64 exec, -1
  v_exp_f32 v35, v35
  v_exp_f32 v36, v36
  v_exp_f32 v37, v37
  s_waitcnt lgkmcnt(4)
  v_smfmac_f32_32x32x32_bf16 v[40:55], v[64:67], v[24:31], v4
  v_exp_f32 v38, v38
  v_exp_f32 v39, v39
  buffer_load_dwordx4 v254, s[24:27], s57 offen sc1 lds
  s_add_u32 m0, m0, 1024
  s_add_u32 s57, s57, 655360
  s_add_u32 m0, m0, 35840
  s_setprio 1
  v_exp_f32 v8, v8
  v_exp_f32 v9, v9
  v_smfmac_f32_32x32x32_bf16 v[40:55], v[68:71], v[32:39], v4
  v_exp_f32 v10, v10
  s_mov_b64 exec, s[60:61]
  ds_read_b128 v[64:67], v3 offset:7680
  ds_read_b128 v[68:71], v3 offset:8320
  s_mov_b64 exec, -1
  v_exp_f32 v11, v11
  v_exp_f32 v12, v12
  v_exp_f32 v13, v13
  s_waitcnt lgkmcnt(2)
  v_mfma_f32_32x32x16_bf16 v[24:39], v[76:79], v[72:75], 0
  v_exp_f32 v14, v14
  v_exp_f32 v15, v15
  v_exp_f32 v16, v16
  v_exp_f32 v17, v17
  v_mfma_f32_32x32x8_bf16 v[24:39], v[82:83], v[80:81], v[24:39]
  s_setprio 0
  ds_read2st64_b64 v[76:79], v2 offset0:20 offset1:21
  v_exp_f32 v18, v18
  s_mov_b64 exec, s[62:63]
  ds_read_b64 v[82:83], v2 offset:11264
  s_mov_b64 exec, -1
  v_exp_f32 v19, v19
  v_exp_f32 v20, v20
  v_exp_f32 v21, v21
  s_waitcnt lgkmcnt(4)
  v_smfmac_f32_32x32x32_bf16 v[40:55], v[56:59], v[8:15], v4
  v_exp_f32 v22, v22
  v_exp_f32 v23, v23
  s_mul_i32 s52, s56, 40960
  s_add_u32 s52, s52, 0xd80000
  s_lshl_b32 s53, s48, 10
  s_add_u32 s14, s53, s52
  s_lshr_b32 s53, s48, 2
  s_lshl_b32 s53, s53, 10
  s_add_u32 s52, s52, s53
  s_and_b32 s53, s48, 1
  s_lshl_b32 s53, s53, 9
  s_add_u32 s52, s52, s53
  s_and_b32 s53, s48, 2
  s_lshl_b32 s53, s53, 7
  s_add_u32 s52, s52, s53
  s_add_u32 s15, s52, 32768
  v_mov_b32 v112, -1
  v_mov_b32 v113, -1
  v_mov_b32 v114, -1
  v_mov_b32 v115, -1
  buffer_store_dwordx4 v[112:115], v1, s[24:27], s14 offen sc1
  s_mov_b64 exec, 0xffff
  buffer_store_dwordx4 v[112:115], v1, s[24:27], s15 offen sc1
  s_mov_b64 exec, -1
  s_setprio 1
  v_exp_f32 v24, v24
  v_exp_f32 v25, v25
  v_smfmac_f32_32x32x32_bf16 v[40:55], v[60:63], v[16:23], v4
  v_exp_f32 v26, v26
  s_mov_b64 exec, s[60:61]
  ds_read_b128 v[56:59], v3 offset:10240
  ds_read_b128 v[60:63], v3 offset:10880
  s_mov_b64 exec, -1
  v_exp_f32 v27, v27
  v_exp_f32 v28, v28
  v_exp_f32 v29, v29
  s_waitcnt lgkmcnt(2)
  v_mfma_f32_32x32x16_bf16 v[8:23], v[76:79], v[72:75], 0
  v_exp_f32 v30, v30
  v_exp_f32 v31, v31
  v_exp_f32 v32, v32
  v_exp_f32 v33, v33
  v_mfma_f32_32x32x8_bf16 v[8:23], v[82:83], v[80:81], v[8:23]
  s_setprio 0
  ds_read2st64_b64 v[76:79], v2 offset0:25 offset1:26
  v_exp_f32 v34, v34
  s_mov_b64 exec, s[62:63]
  ds_read_b64 v[82:83], v2 offset:13824
  s_mov_b64 exec, -1
  v_exp_f32 v35, v35
  v_exp_f32 v36, v36
  v_exp_f32 v37, v37
  s_waitcnt lgkmcnt(4)
  v_smfmac_f32_32x32x32_bf16 v[40:55], v[64:67], v[24:31], v4
  v_exp_f32 v38, v38
  v_exp_f32 v39, v39
  s_nop 0
  s_nop 0
  s_setprio 1
  v_exp_f32 v8, v8
  v_exp_f32 v9, v9
  v_smfmac_f32_32x32x32_bf16 v[40:55], v[68:71], v[32:39], v4
  v_exp_f32 v10, v10
  s_mov_b64 exec, s[60:61]
  ds_read_b128 v[64:67], v3 offset:12800
  ds_read_b128 v[68:71], v3 offset:13440
  s_mov_b64 exec, -1
  v_exp_f32 v11, v11
  v_exp_f32 v12, v12
  v_exp_f32 v13, v13
  s_waitcnt lgkmcnt(2)
  v_mfma_f32_32x32x16_bf16 v[24:39], v[76:79], v[72:75], 0
  v_exp_f32 v14, v14
  v_exp_f32 v15, v15
  v_exp_f32 v16, v16
  v_exp_f32 v17, v17
  v_mfma_f32_32x32x8_bf16 v[24:39], v[82:83], v[80:81], v[24:39]
  s_setprio 0
  ds_read2st64_b64 v[76:79], v2 offset0:30 offset1:31
  v_exp_f32 v18, v18
  s_mov_b64 exec, s[62:63]
  ds_read_b64 v[82:83], v2 offset:16384
  s_mov_b64 exec, -1
  v_exp_f32 v19, v19
  v_exp_f32 v20, v20
  v_exp_f32 v21, v21
  s_waitcnt lgkmcnt(4)
  v_smfmac_f32_32x32x32_bf16 v[40:55], v[56:59], v[8:15], v4
  v_exp_f32 v22, v22
  v_exp_f32 v23, v23
  s_nop 0
  s_nop 0
  s_setprio 1
  v_exp_f32 v24, v24
  v_exp_f32 v25, v25
  v_smfmac_f32_32x32x32_bf16 v[40:55], v[60:63], v[16:23], v4
  v_exp_f32 v26, v26
  s_mov_b64 exec, s[60:61]
  ds_read_b128 v[56:59], v3 offset:15360
  ds_read_b128 v[60:63], v3 offset:16000
  s_mov_b64 exec, -1
  v_exp_f32 v27, v27
  v_exp_f32 v28, v28
  v_exp_f32 v29, v29
  s_waitcnt lgkmcnt(2)
  v_mfma_f32_32x32x16_bf16 v[8:23], v[76:79], v[72:75], 0
  v_exp_f32 v30, v30
  v_exp_f32 v31, v31
  v_exp_f32 v32, v32
  v_exp_f32 v33, v33
  v_mfma_f32_32x32x8_bf16 v[8:23], v[82:83], v[80:81], v[8:23]
  s_setprio 0
  ds_read2st64_b64 v[76:79], v2 offset0:35 offset1:36
  v_exp_f32 v34, v34
  s_mov_b64 exec, s[62:63]
  ds_read_b64 v[82:83], v2 offset:18944
  s_mov_b64 exec, -1
  v_exp_f32 v35, v35
  v_exp_f32 v36, v36
  v_exp_f32 v37, v37
  s_waitcnt lgkmcnt(4)
  v_smfmac_f32_32x32x32_bf16 v[40:55], v[64:67], v[24:31], v4
  v_exp_f32 v38, v38
  v_exp_f32 v39, v39
  s_and_b32 s52, s2, 7
  s_lshl_b32 s52, s52, 8
  s_add_u32 s54, s52, 0x12c8000
  v_lshlrev_b32 v7, 11, v0
  s_mov_b64 exec, 0xffff
  buffer_load_dword v7, v7, s[24:27], s54 offen sc1
  s_mov_b64 exec, -1
  s_setprio 1
  v_exp_f32 v8, v8
  v_exp_f32 v9, v9
  v_smfmac_f32_32x32x32_bf16 v[40:55], v[68:71], v[32:39], v4
  v_exp_f32 v10, v10
  s_mov_b64 exec, s[60:61]
  ds_read_b128 v[64:67], v3 offset:17920
  ds_read_b128 v[68:71], v3 offset:18560
  s_mov_b64 exec, -1
  v_exp_f32 v11, v11
  v_exp_f32 v12, v12
  v_exp_f32 v13, v13
  s_waitcnt lgkmcnt(2)
  v_mfma_f32_32x32x16_bf16 v[24:39], v[76:79], v[72:75], 0
  v_exp_f32 v14, v14
  v_exp_f32 v15, v15
  v_exp_f32 v16, v16
  v_exp_f32 v17, v17
  v_mfma_f32_32x32x8_bf16 v[24:39], v[82:83], v[80:81], v[24:39]
  s_setprio 0
  ds_read2st64_b64 v[76:79], v2 offset0:40 offset1:41
  v_exp_f32 v18, v18
  s_mov_b64 exec, s[62:63]
  ds_read_b64 v[82:83], v2 offset:21504
  s_mov_b64 exec, -1
  v_exp_f32 v19, v19
  v_exp_f32 v20, v20
  v_exp_f32 v21, v21
  s_waitcnt lgkmcnt(4)
  v_smfmac_f32_32x32x32_bf16 v[40:55], v[56:59], v[8:15], v4
  v_exp_f32 v22, v22
  v_exp_f32 v23, v23
  s_nop 0
  s_nop 0
  s_setprio 1
  v_exp_f32 v24, v24
  v_exp_f32 v25, v25
  v_smfmac_f32_32x32x32_bf16 v[40:55], v[60:63], v[16:23], v4
  v_exp_f32 v26, v26
  s_mov_b64 exec, s[60:61]
  ds_read_b128 v[56:59], v3 offset:20480
  ds_read_b128 v[60:63], v3 offset:21120
  s_mov_b64 exec, -1
  v_exp_f32 v27, v27
  v_exp_f32 v28, v28
  v_exp_f32 v29, v29
  s_waitcnt lgkmcnt(2)
  v_mfma_f32_32x32x16_bf16 v[8:23], v[76:79], v[72:75], 0
  v_exp_f32 v30, v30
  v_exp_f32 v31, v31
  v_exp_f32 v32, v32
  v_exp_f32 v33, v33
  v_mfma_f32_32x32x8_bf16 v[8:23], v[82:83], v[80:81], v[8:23]
  s_setprio 0
  ds_read2st64_b64 v[76:79], v2 offset0:45 offset1:46
  v_exp_f32 v34, v34
  s_mov_b64 exec, s[62:63]
  ds_read_b64 v[82:83], v2 offset:24064
  s_mov_b64 exec, -1
  v_exp_f32 v35, v35
  v_exp_f32 v36, v36
  v_exp_f32 v37, v37
  s_waitcnt lgkmcnt(4)
  v_smfmac_f32_32x32x32_bf16 v[40:55], v[64:67], v[24:31], v4
  v_exp_f32 v38, v38
  v_exp_f32 v39, v39
  s_nop 0
  s_nop 0
  s_setprio 1
  v_exp_f32 v8, v8
  v_exp_f32 v9, v9
  v_smfmac_f32_32x32x32_bf16 v[40:55], v[68:71], v[32:39], v4
  v_exp_f32 v10, v10
  s_mov_b64 exec, s[60:61]
  ds_read_b128 v[64:67], v3 offset:23040
  ds_read_b128 v[68:71], v3 offset:23680
  s_mov_b64 exec, -1
  v_exp_f32 v11, v11
  v_exp_f32 v12, v12
  v_exp_f32 v13, v13
  s_waitcnt lgkmcnt(2)
  v_mfma_f32_32x32x16_bf16 v[24:39], v[76:79], v[72:75], 0
  v_exp_f32 v14, v14
  v_exp_f32 v15, v15
  v_exp_f32 v16, v16
  v_exp_f32 v17, v17
  v_mfma_f32_32x32x8_bf16 v[24:39], v[82:83], v[80:81], v[24:39]
  s_setprio 0
  ds_read2st64_b64 v[76:79], v2 offset0:50 offset1:51
  v_exp_f32 v18, v18
  s_mov_b64 exec, s[62:63]
  ds_read_b64 v[82:83], v2 offset:26624
  s_mov_b64 exec, -1
  v_exp_f32 v19, v19
  v_exp_f32 v20, v20
  v_exp_f32 v21, v21
  s_waitcnt lgkmcnt(4)
  v_smfmac_f32_32x32x32_bf16 v[40:55], v[56:59], v[8:15], v4
  v_exp_f32 v22, v22
  v_exp_f32 v23, v23
  s_waitcnt vmcnt(0)
  s_mov_b64 exec, 0xffff
  v_cmp_gt_u32 vcc, 16, v7
  s_mov_b64 exec, -1
  s_lshl_b32 s52, s56, 9
  s_lshl_b32 s53, s50, 9
  s_cbranch_vccnz L_h_spin
L_h_ok:
  s_add_u32 s52, s52, 0x1000000
  s_add_u32 s53, s53, 0x1000000
  buffer_load_dword v5, v5, s[24:27], s52 offen sc1
  buffer_load_dword v6, v6, s[24:27], s53 offen sc1
  s_lshl_b32 s52, s56, 8
  s_add_u32 s52, s52, 0x12d0000
  v_mov_b32 v85, 1
  s_mov_b64 exec, 1
  buffer_atomic_add v85, off, s[24:27], s52 sc1
  s_mov_b64 exec, -1
  s_setprio 1
  v_exp_f32 v24, v24
  v_exp_f32 v25, v25
  v_smfmac_f32_32x32x32_bf16 v[40:55], v[60:63], v[16:23], v4
  v_exp_f32 v26, v26
  s_mov_b64 exec, s[60:61]
  ds_read_b128 v[56:59], v3 offset:25600
  ds_read_b128 v[60:63], v3 offset:26240
  s_mov_b64 exec, -1
  v_exp_f32 v27, v27
  v_exp_f32 v28, v28
  v_exp_f32 v29, v29
  s_waitcnt lgkmcnt(2)
  v_mfma_f32_32x32x16_bf16 v[8:23], v[76:79], v[72:75], 0
  v_exp_f32 v30, v30
  v_exp_f32 v31, v31
  v_exp_f32 v32, v32
  v_exp_f32 v33, v33
  v_mfma_f32_32x32x8_bf16 v[8:23], v[82:83], v[80:81], v[8:23]
  s_setprio 0
  ds_read2st64_b64 v[76:79], v2 offset0:55 offset1:56
  v_exp_f32 v34, v34
  s_mov_b64 exec, s[62:63]
  ds_read_b64 v[82:83], v2 offset:29184
  s_mov_b64 exec, -1
  v_exp_f32 v35, v35
  v_exp_f32 v36, v36
  v_exp_f32 v37, v37
  s_waitcnt lgkmcnt(4)
  v_smfmac_f32_32x32x32_bf16 v[40:55], v[64:67], v[24:31], v4
  v_exp_f32 v38, v38
  v_exp_f32 v39, v39
  buffer_load_dwordx4 v[84:87], v1, s[24:27], s58 offen offset:0 sc1
  s_nop 0
  s_setprio 1
  v_exp_f32 v8, v8
  v_exp_f32 v9, v9
  v_smfmac_f32_32x32x32_bf16 v[40:55], v[68:71], v[32:39], v4
  v_exp_f32 v10, v10
  s_mov_b64 exec, s[60:61]
  ds_read_b128 v[64:67], v3 offset:28160
  ds_read_b128 v[68:71], v3 offset:28800
  s_mov_b64 exec, -1
  v_exp_f32 v11, v11
  v_exp_f32 v12, v12
  v_exp_f32 v13, v13
  s_waitcnt lgkmcnt(2)
  v_mfma_f32_32x32x16_bf16 v[24:39], v[76:79], v[72:75], 0
  v_exp_f32 v14, v14
  v_exp_f32 v15, v15
  v_exp_f32 v16, v16
  v_exp_f32 v17, v17
  v_mfma_f32_32x32x8_bf16 v[24:39], v[82:83], v[80:81], v[24:39]
  s_setprio 0
  ds_read2st64_b64 v[76:79], v2 offset0:60 offset1:61
  v_exp_f32 v18, v18
  s_mov_b64 exec, s[62:63]
  ds_read_b64 v[82:83], v2 offset:31744
  s_mov_b64 exec, -1
  v_exp_f32 v19, v19
  v_exp_f32 v20, v20
  v_exp_f32 v21, v21
  s_waitcnt lgkmcnt(4)
  v_smfmac_f32_32x32x32_bf16 v[40:55], v[56:59], v[8:15], v4
  v_exp_f32 v22, v22
  v_exp_f32 v23, v23
  buffer_load_dwordx4 v[88:91], v1, s[24:27], s58 offen offset:1024 sc1
  s_nop 0
  s_setprio 1
  v_exp_f32 v24, v24
  v_exp_f32 v25, v25
  v_smfmac_f32_32x32x32_bf16 v[40:55], v[60:63], v[16:23], v4
  v_exp_f32 v26, v26
  s_mov_b64 exec, s[60:61]
  ds_read_b128 v[56:59], v3 offset:30720
  ds_read_b128 v[60:63], v3 offset:31360
  s_mov_b64 exec, -1
  v_exp_f32 v27, v27
  v_exp_f32 v28, v28
  v_exp_f32 v29, v29
  s_waitcnt lgkmcnt(2)
  v_mfma_f32_32x32x16_bf16 v[8:23], v[76:79], v[72:75], 0
  v_exp_f32 v30, v30
  v_exp_f32 v31, v31
  v_exp_f32 v32, v32
  v_exp_f32 v33, v33
  v_mfma_f32_32x32x8_bf16 v[8:23], v[82:83], v[80:81], v[8:23]
  s_setprio 0
  ds_read2st64_b64 v[76:79], v2 offset0:65 offset1:66
  v_exp_f32 v34, v34
  s_mov_b64 exec, s[62:63]
  ds_read_b64 v[82:83], v2 offset:34304
  s_mov_b64 exec, -1
  v_exp_f32 v35, v35
  v_exp_f32 v36, v36
  v_exp_f32 v37, v37
  s_waitcnt lgkmcnt(4)
  v_smfmac_f32_32x32x32_bf16 v[40:55], v[64:67], v[24:31], v4
  v_exp_f32 v38, v38
  v_exp_f32 v39, v39
  buffer_load_dwordx4 v[92:95], v1, s[24:27], s58 offen offset:2048 sc1
  s_nop 0
  s_setprio 1
  v_exp_f32 v8, v8
  v_exp_f32 v9, v9
  v_smfmac_f32_32x32x32_bf16 v[40:55], v[68:71], v[32:39], v4
  v_exp_f32 v10, v10
  s_mov_b64 exec, s[60:61]
  ds_read_b128 v[64:67], v3 offset:33280
  ds_read_b128 v[68:71], v3 offset:33920
  s_mov_b64 exec, -1
  v_exp_f32 v11, v11
  v_exp_f32 v12, v12
  v_exp_f32 v13, v13
  s_waitcnt lgkmcnt(2)
  v_mfma_f32_32x32x16_bf16 v[24:39], v[76:79], v[72:75], 0
  v_exp_f32 v14, v14
  v_exp_f32 v15, v15
  v_exp_f32 v16, v16
  v_exp_f32 v17, v17
  v_mfma_f32_32x32x8_bf16 v[24:39], v[82:83], v[80:81], v[24:39]
  s_setprio 0
  ds_read2st64_b64 v[76:79], v2 offset0:70 offset1:71
  v_exp_f32 v18, v18
  s_mov_b64 exec, s[62:63]
  ds_read_b64 v[82:83], v2 offset:36864
  s_mov_b64 exec, -1
  v_exp_f32 v19, v19
  v_exp_f32 v20, v20
  v_exp_f32 v21, v21
  s_waitcnt lgkmcnt(4)
  v_smfmac_f32_32x32x32_bf16 v[40:55], v[56:59], v[8:15], v4
  v_exp_f32 v22, v22
  v_exp_f32 v23, v23
  buffer_load_dwordx4 v[96:99], v1, s[24:27], s58 offen offset:3072 sc1
  s_add_u32 s58, s58, 4096
  s_setprio 1
  v_exp_f32 v24, v24
  v_exp_f32 v25, v25
  v_smfmac_f32_32x32x32_bf16 v[40:55], v[60:63], v[16:23], v4
  v_exp_f32 v26, v26
  s_mov_b64 exec, s[60:61]
  ds_read_b128 v[56:59], v3 offset:35840
  ds_read_b128 v[60:63], v3 offset:36480
  s_mov_b64 exec, -1
  v_exp_f32 v27, v27
  v_exp_f32 v28, v28
  v_exp_f32 v29, v29
  s_waitcnt lgkmcnt(2)
  v_mfma_f32_32x32x16_bf16 v[8:23], v[76:79], v[72:75], 0
  v_exp_f32 v30, v30
  v_exp_f32 v31, v31
  v_exp_f32 v32, v32
  v_exp_f32 v33, v33
  v_mfma_f32_32x32x8_bf16 v[8:23], v[82:83], v[80:81], v[8:23]
  s_setprio 0
  ds_read2st64_b64 v[76:79], v2 offset0:75 offset1:76
  v_exp_f32 v34, v34
  s_mov_b64 exec, s[62:63]
  ds_read_b64 v[82:83], v2 offset:39424
  s_mov_b64 exec, -1
  v_exp_f32 v35, v35
  v_exp_f32 v36, v36
  v_exp_f32 v37, v37
  s_waitcnt lgkmcnt(4)
  v_smfmac_f32_32x32x32_bf16 v[40:55], v[64:67], v[24:31], v4
  v_exp_f32 v38, v38
  v_exp_f32 v39, v39
  buffer_load_dwordx4 v[100:103], v1, s[24:27], s58 offen offset:0 sc1
  s_nop 0
  s_setprio 1
  v_exp_f32 v8, v8
  v_exp_f32 v9, v9
  v_smfmac_f32_32x32x32_bf16 v[40:55], v[68:71], v[32:39], v4
  v_exp_f32 v10, v10
  s_mov_b64 exec, s[60:61]
  ds_read_b128 v[64:67], v3 offset:38400
  ds_read_b128 v[68:71], v3 offset:39040
  s_mov_b64 exec, -1
  v_exp_f32 v11, v11
  v_exp_f32 v12, v12
  v_exp_f32 v13, v13
  s_waitcnt lgkmcnt(2)
  v_mfma_f32_32x32x16_bf16 v[24:39], v[76:79], v[72:75], 0
  v_exp_f32 v14, v14
  v_exp_f32 v15, v15
  v_exp_f32 v16, v16
  v_exp_f32 v17, v17
  v_mfma_f32_32x32x8_bf16 v[24:39], v[82:83], v[80:81], v[24:39]
  s_setprio 0
  ds_read2st64_b64 v[76:79], v2 offset0:80 offset1:81
  v_exp_f32 v18, v18
  s_mov_b64 exec, s[62:63]
  ds_read_b64 v[82:83], v2 offset:41984
  s_mov_b64 exec, -1
  v_exp_f32 v19, v19
  v_exp_f32 v20, v20
  v_exp_f32 v21, v21
  s_waitcnt lgkmcnt(4)
  v_smfmac_f32_32x32x32_bf16 v[40:55], v[56:59], v[8:15], v4
  v_exp_f32 v22, v22
  v_exp_f32 v23, v23
  buffer_load_dwordx4 v[104:107], v1, s[24:27], s58 offen offset:1024 sc1
  s_nop 0
  s_setprio 1
  v_exp_f32 v24, v24
  v_exp_f32 v25, v25
  v_smfmac_f32_32x32x32_bf16 v[40:55], v[60:63], v[16:23], v4
  v_exp_f32 v26, v26
  s_mov_b64 exec, s[60:61]
  ds_read_b128 v[56:59], v3 offset:40960
  ds_read_b128 v[60:63], v3 offset:41600
  s_mov_b64 exec, -1
  v_exp_f32 v27, v27
  v_exp_f32 v28, v28
  v_exp_f32 v29, v29
  s_waitcnt lgkmcnt(2)
  v_mfma_f32_32x32x16_bf16 v[8:23], v[76:79], v[72:75], 0
  v_exp_f32 v30, v30
  v_exp_f32 v31, v31
  v_exp_f32 v32, v32
  v_exp_f32 v33, v33
  v_mfma_f32_32x32x8_bf16 v[8:23], v[82:83], v[80:81], v[8:23]
  s_setprio 0
  ds_read2st64_b64 v[76:79], v2 offset0:85 offset1:86
  v_exp_f32 v34, v34
  s_mov_b64 exec, s[62:63]
  ds_read_b64 v[82:83], v2 offset:44544
  s_mov_b64 exec, -1
  v_exp_f32 v35, v35
  v_exp_f32 v36, v36
  v_exp_f32 v37, v37
  s_waitcnt lgkmcnt(4)
  v_smfmac_f32_32x32x32_bf16 v[40:55], v[64:67], v[24:31], v4
  v_exp_f32 v38, v38
  v_exp_f32 v39, v39
  buffer_load_dwordx4 v[108:111], v1, s[24:27], s58 offen offset:2048 sc1
  v_add_u32 v2, 40960, v2
  v_add_u32 v3, 40960, v3
  s_setprio 1
  v_exp_f32 v8, v8
  v_exp_f32 v9, v9
  v_smfmac_f32_32x32x32_bf16 v[40:55], v[68:71], v[32:39], v4
  v_exp_f32 v10, v10
  s_mov_b64 exec, s[60:61]
  ds_read_b128 v[64:67], v3 offset:2560
  ds_read_b128 v[68:71], v3 offset:3200
  s_mov_b64 exec, -1
  v_exp_f32 v11, v11
  v_exp_f32 v12, v12
  v_exp_f32 v13, v13
  s_waitcnt lgkmcnt(2)
  v_mfma_f32_32x32x16_bf16 v[24:39], v[76:79], v[72:75], 0
  v_exp_f32 v14, v14
  v_exp_f32 v15, v15
  v_exp_f32 v16, v16
  v_exp_f32 v17, v17
  v_mfma_f32_32x32x8_bf16 v[24:39], v[82:83], v[80:81], v[24:39]
  s_setprio 0
  ds_read2st64_b64 v[76:79], v2 offset0:10 offset1:11
  v_exp_f32 v18, v18
  s_mov_b64 exec, s[62:63]
  ds_read_b64 v[82:83], v2 offset:6144
  s_mov_b64 exec, -1
  v_exp_f32 v19, v19
  v_exp_f32 v20, v20
  v_exp_f32 v21, v21
  s_waitcnt lgkmcnt(4)
  v_smfmac_f32_32x32x32_bf16 v[40:55], v[56:59], v[8:15], v4
  v_exp_f32 v22, v22
  v_exp_f32 v23, v23
  buffer_load_dwordx4 v[112:115], v1, s[24:27], s58 offen offset:3072 sc1
  s_add_u32 s58, s58, 4096
  s_setprio 1
  v_exp_f32 v24, v24
  v_exp_f32 v25, v25
  v_smfmac_f32_32x32x32_bf16 v[40:55], v[60:63], v[16:23], v4
  v_exp_f32 v26, v26
  s_mov_b64 exec, s[60:61]
  ds_read_b128 v[56:59], v3 offset:5120
  ds_read_b128 v[60:63], v3 offset:5760
  s_mov_b64 exec, -1
  v_exp_f32 v27, v27
  v_exp_f32 v28, v28
  v_exp_f32 v29, v29
  s_waitcnt lgkmcnt(2)
  v_mfma_f32_32x32x16_bf16 v[8:23], v[76:79], v[72:75], 0
  v_exp_f32 v30, v30
  v_exp_f32 v31, v31
  v_exp_f32 v32, v32
  v_exp_f32 v33, v33
  v_mfma_f32_32x32x8_bf16 v[8:23], v[82:83], v[80:81], v[8:23]
  s_setprio 0
  ds_read2st64_b64 v[76:79], v2 offset0:15 offset1:16
  v_exp_f32 v34, v34
  s_mov_b64 exec, s[62:63]
  ds_read_b64 v[82:83], v2 offset:8704
  s_mov_b64 exec, -1
  v_exp_f32 v35, v35
  v_exp_f32 v36, v36
  v_exp_f32 v37, v37
  s_waitcnt lgkmcnt(4)
  v_smfmac_f32_32x32x32_bf16 v[40:55], v[64:67], v[24:31], v4
  v_exp_f32 v38, v38
  v_exp_f32 v39, v39
  buffer_load_dwordx4 v[116:119], v1, s[24:27], s58 offen offset:0 sc1
  s_nop 0
  s_setprio 1
  v_exp_f32 v8, v8
  v_exp_f32 v9, v9
  v_smfmac_f32_32x32x32_bf16 v[40:55], v[68:71], v[32:39], v4
  v_exp_f32 v10, v10
  s_mov_b64 exec, s[60:61]
  ds_read_b128 v[64:67], v3 offset:7680
  ds_read_b128 v[68:71], v3 offset:8320
  s_mov_b64 exec, -1
  v_exp_f32 v11, v11
  v_exp_f32 v12, v12
  v_exp_f32 v13, v13
  s_waitcnt lgkmcnt(2)
  v_mfma_f32_32x32x16_bf16 v[24:39], v[76:79], v[72:75], 0
  v_exp_f32 v14, v14
  v_exp_f32 v15, v15
  v_exp_f32 v16, v16
  v_exp_f32 v17, v17
  v_mfma_f32_32x32x8_bf16 v[24:39], v[82:83], v[80:81], v[24:39]
  s_setprio 0
  ds_read2st64_b64 v[76:79], v2 offset0:20 offset1:21
  v_exp_f32 v18, v18
  s_mov_b64 exec, s[62:63]
  ds_read_b64 v[82:83], v2 offset:11264
  s_mov_b64 exec, -1
  v_exp_f32 v19, v19
  v_exp_f32 v20, v20
  v_exp_f32 v21, v21
  s_waitcnt lgkmcnt(4)
  v_smfmac_f32_32x32x32_bf16 v[40:55], v[56:59], v[8:15], v4
  v_exp_f32 v22, v22
  v_exp_f32 v23, v23
  buffer_load_dwordx4 v[120:123], v1, s[24:27], s58 offen offset:1024 sc1
  s_nop 0
  s_setprio 1
  v_exp_f32 v24, v24
  v_exp_f32 v25, v25
  v_smfmac_f32_32x32x32_bf16 v[40:55], v[60:63], v[16:23], v4
  v_exp_f32 v26, v26
  s_mov_b64 exec, s[60:61]
  ds_read_b128 v[56:59], v3 offset:10240
  ds_read_b128 v[60:63], v3 offset:10880
  s_mov_b64 exec, -1
  v_exp_f32 v27, v27
  v_exp_f32 v28, v28
  v_exp_f32 v29, v29
  s_waitcnt lgkmcnt(2)
  v_mfma_f32_32x32x16_bf16 v[8:23], v[76:79], v[72:75], 0
  v_exp_f32 v30, v30
  v_exp_f32 v31, v31
  v_exp_f32 v32, v32
  v_exp_f32 v33, v33
  v_mfma_f32_32x32x8_bf16 v[8:23], v[82:83], v[80:81], v[8:23]
  s_setprio 0
  ds_read2st64_b64 v[76:79], v2 offset0:25 offset1:26
  v_exp_f32 v34, v34
  s_mov_b64 exec, s[62:63]
  ds_read_b64 v[82:83], v2 offset:13824
  s_mov_b64 exec, -1
  v_exp_f32 v35, v35
  v_exp_f32 v36, v36
  v_exp_f32 v37, v37
  s_waitcnt lgkmcnt(4)
  v_smfmac_f32_32x32x32_bf16 v[40:55], v[64:67], v[24:31], v4
  v_exp_f32 v38, v38
  v_exp_f32 v39, v39
  buffer_load_dwordx4 v[124:127], v1, s[24:27], s58 offen offset:2048 sc1
  s_nop 0
  s_setprio 1
  v_exp_f32 v8, v8
  v_exp_f32 v9, v9
  v_smfmac_f32_32x32x32_bf16 v[40:55], v[68:71], v[32:39], v4
  v_exp_f32 v10, v10
  s_mov_b64 exec, s[60:61]
  ds_read_b128 v[64:67], v3 offset:12800
  ds_read_b128 v[68:71], v3 offset:13440
  s_mov_b64 exec, -1
  v_exp_f32 v11, v11
  v_exp_f32 v12, v12
  v_exp_f32 v13, v13
  s_waitcnt lgkmcnt(2)
  v_mfma_f32_32x32x16_bf16 v[24:39], v[76:79], v[72:75], 0
  v_exp_f32 v14, v14
  v_exp_f32 v15, v15
  v_exp_f32 v16, v16
  v_exp_f32 v17, v17
  v_mfma_f32_32x32x8_bf16 v[24:39], v[82:83], v[80:81], v[24:39]
  s_setprio 0
  ds_read2st64_b64 v[76:79], v2 offset0:30 offset1:31
  v_exp_f32 v18, v18
  s_mov_b64 exec, s[62:63]
  ds_read_b64 v[82:83], v2 offset:16384
  s_mov_b64 exec, -1
  v_exp_f32 v19, v19
  v_exp_f32 v20, v20
  v_exp_f32 v21, v21
  s_waitcnt lgkmcnt(4)
  v_smfmac_f32_32x32x32_bf16 v[40:55], v[56:59], v[8:15], v4
  v_exp_f32 v22, v22
  v_exp_f32 v23, v23
  buffer_load_dwordx4 v[128:131], v1, s[24:27], s58 offen offset:3072 sc1
  s_cmp_eq_u32 s96, 1
  s_cselect_b32 s55, s101, 4096
  s_add_u32 s58, s58, s55
  s_setprio 1
  v_exp_f32 v24, v24
  v_exp_f32 v25, v25
  v_smfmac_f32_32x32x32_bf16 v[40:55], v[60:63], v[16:23], v4
  v_exp_f32 v26, v26
  s_mov_b64 exec, s[60:61]
  ds_read_b128 v[56:59], v3 offset:15360
  ds_read_b128 v[60:63], v3 offset:16000
  s_mov_b64 exec, -1
  v_exp_f32 v27, v27
  v_exp_f32 v28, v28
  v_exp_f32 v29, v29
  s_waitcnt lgkmcnt(2)
  v_mfma_f32_32x32x16_bf16 v[8:23], v[76:79], v[72:75], 0
  v_exp_f32 v30, v30
  v_exp_f32 v31, v31
  v_exp_f32 v32, v32
  v_exp_f32 v33, v33
  v_mfma_f32_32x32x8_bf16 v[8:23], v[82:83], v[80:81], v[8:23]
  s_setprio 0
  ds_read2st64_b64 v[76:79], v2 offset0:35 offset1:36
  v_exp_f32 v34, v34
  s_mov_b64 exec, s[62:63]
  ds_read_b64 v[82:83], v2 offset:18944
  s_mov_b64 exec, -1
  v_exp_f32 v35, v35
  v_exp_f32 v36, v36
  v_exp_f32 v37, v37
  s_waitcnt lgkmcnt(4)
  v_smfmac_f32_32x32x32_bf16 v[40:55], v[64:67], v[24:31], v4
  v_exp_f32 v38, v38
  v_exp_f32 v39, v39
  buffer_load_dwordx4 v[132:135], v1, s[24:27], s58 offen offset:0 sc1
  buffer_load_dwordx4 v[136:139], v1, s[24:27], s58 offen offset:1024 sc1
  s_setprio 1
  v_exp_f32 v8, v8
  v_exp_f32 v9, v9
  v_smfmac_f32_32x32x32_bf16 v[40:55], v[68:71], v[32:39], v4
  v_exp_f32 v10, v10
  s_mov_b64 exec, s[60:61]
  ds_read_b128 v[64:67], v3 offset:17920
  ds_read_b128 v[68:71], v3 offset:18560
  s_mov_b64 exec, -1
  v_exp_f32 v11, v11
  v_exp_f32 v12, v12
  v_exp_f32 v13, v13
  s_waitcnt lgkmcnt(2)
  v_mfma_f32_32x32x16_bf16 v[24:39], v[76:79], v[72:75], 0
  v_exp_f32 v14, v14
  v_exp_f32 v15, v15
  v_exp_f32 v16, v16
  v_exp_f32 v17, v17
  v_mfma_f32_32x32x8_bf16 v[24:39], v[82:83], v[80:81], v[24:39]
  s_setprio 0
  ds_read2st64_b64 v[76:79], v2 offset0:40 offset1:41
  v_exp_f32 v18, v18
  s_mov_b64 exec, s[62:63]
  ds_read_b64 v[82:83], v2 offset:21504
  s_mov_b64 exec, -1
  v_exp_f32 v19, v19
  v_exp_f32 v20, v20
  v_exp_f32 v21, v21
  s_waitcnt lgkmcnt(4)
  v_smfmac_f32_32x32x32_bf16 v[40:55], v[56:59], v[8:15], v4
  v_exp_f32 v22, v22
  v_exp_f32 v23, v23
  buffer_load_dwordx4 v[140:143], v1, s[24:27], s58 offen offset:2048 sc1
  buffer_load_dwordx4 v[144:147], v1, s[24:27], s58 offen offset:3072 sc1
  s_add_u32 s58, s58, 4096
  s_setprio 1
  v_exp_f32 v24, v24
  v_exp_f32 v25, v25
  v_smfmac_f32_32x32x32_bf16 v[40:55], v[60:63], v[16:23], v4
  v_exp_f32 v26, v26
  s_mov_b64 exec, s[60:61]
  ds_read_b128 v[56:59], v3 offset:20480
  ds_read_b128 v[60:63], v3 offset:21120
  s_mov_b64 exec, -1
  v_exp_f32 v27, v27
  v_exp_f32 v28, v28
  v_exp_f32 v29, v29
  s_waitcnt lgkmcnt(2)
  v_mfma_f32_32x32x16_bf16 v[8:23], v[76:79], v[72:75], 0
  v_exp_f32 v30, v30
  v_exp_f32 v31, v31
  v_exp_f32 v32, v32
  v_exp_f32 v33, v33
  v_mfma_f32_32x32x8_bf16 v[8:23], v[82:83], v[80:81], v[8:23]
  s_setprio 0
  ds_read2st64_b64 v[76:79], v2 offset0:45 offset1:46
  v_exp_f32 v34, v34
  s_mov_b64 exec, s[62:63]
  ds_read_b64 v[82:83], v2 offset:24064
  s_mov_b64 exec, -1
  v_exp_f32 v35, v35
  v_exp_f32 v36, v36
  v_exp_f32 v37, v37
  s_waitcnt lgkmcnt(4)
  v_smfmac_f32_32x32x32_bf16 v[40:55], v[64:67], v[24:31], v4
  v_exp_f32 v38, v38
  v_exp_f32 v39, v39
  buffer_load_dwordx4 v[148:151], v1, s[24:27], s58 offen offset:0 sc1
  buffer_load_dwordx4 v[152:155], v1, s[24:27], s58 offen offset:1024 sc1
  s_setprio 1
  v_exp_f32 v8, v8
  v_exp_f32 v9, v9
  v_smfmac_f32_32x32x32_bf16 v[40:55], v[68:71], v[32:39], v4
  v_exp_f32 v10, v10
  s_mov_b64 exec, s[60:61]
  ds_read_b128 v[64:67], v3 offset:23040
  ds_read_b128 v[68:71], v3 offset:23680
  s_mov_b64 exec, -1
  v_exp_f32 v11, v11
  v_exp_f32 v12, v12
  v_exp_f32 v13, v13
  s_waitcnt lgkmcnt(2)
  v_mfma_f32_32x32x16_bf16 v[24:39], v[76:79], v[72:75], 0
  v_exp_f32 v14, v14
  v_exp_f32 v15, v15
  v_exp_f32 v16, v16
  v_exp_f32 v17, v17
  v_mfma_f32_32x32x8_bf16 v[24:39], v[82:83], v[80:81], v[24:39]
  s_setprio 0
  ds_read2st64_b64 v[76:79], v2 offset0:50 offset1:51
  v_exp_f32 v18, v18
  s_mov_b64 exec, s[62:63]
  ds_read_b64 v[82:83], v2 offset:26624
  s_mov_b64 exec, -1
  v_exp_f32 v19, v19
  v_exp_f32 v20, v20
  v_exp_f32 v21, v21
  s_waitcnt lgkmcnt(4)
  v_smfmac_f32_32x32x32_bf16 v[40:55], v[56:59], v[8:15], v4
  v_exp_f32 v22, v22
  v_exp_f32 v23, v23
  buffer_load_dwordx4 v[156:159], v1, s[24:27], s58 offen offset:2048 sc1
  buffer_load_dwordx4 v[160:163], v1, s[24:27], s58 offen offset:3072 sc1
  s_add_u32 s58, s58, 4096
  s_setprio 1
  v_exp_f32 v24, v24
  v_exp_f32 v25, v25
  v_smfmac_f32_32x32x32_bf16 v[40:55], v[60:63], v[16:23], v4
  v_exp_f32 v26, v26
  s_mov_b64 exec, s[60:61]
  ds_read_b128 v[56:59], v3 offset:25600
  ds_read_b128 v[60:63], v3 offset:26240
  s_mov_b64 exec, -1
  v_exp_f32 v27, v27
  v_exp_f32 v28, v28
  v_exp_f32 v29, v29
  s_waitcnt lgkmcnt(2)
  v_mfma_f32_32x32x16_bf16 v[8:23], v[76:79], v[72:75], 0
  v_exp_f32 v30, v30
  v_exp_f32 v31, v31
  v_exp_f32 v32, v32
  v_exp_f32 v33, v33
  v_mfma_f32_32x32x8_bf16 v[8:23], v[82:83], v[80:81], v[8:23]
  s_setprio 0
  ds_read2st64_b64 v[76:79], v2 offset0:55 offset1:56
  v_exp_f32 v34, v34
  s_mov_b64 exec, s[62:63]
  ds_read_b64 v[82:83], v2 offset:29184
  s_mov_b64 exec, -1
  v_exp_f32 v35, v35
  v_exp_f32 v36, v36
  v_exp_f32 v37, v37
  s_waitcnt lgkmcnt(4)
  v_smfmac_f32_32x32x32_bf16 v[40:55], v[64:67], v[24:31], v4
  v_exp_f32 v38, v38
  v_exp_f32 v39, v39
  buffer_load_dwordx4 v[164:167], v1, s[24:27], s58 offen offset:0 sc1
  buffer_load_dwordx4 v[168:171], v1, s[24:27], s58 offen offset:1024 sc1
  s_setprio 1
  v_exp_f32 v8, v8
  v_exp_f32 v9, v9
  v_smfmac_f32_32x32x32_bf16 v[40:55], v[68:71], v[32:39], v4
  v_exp_f32 v10, v10
  s_mov_b64 exec, s[60:61]
  ds_read_b128 v[64:67], v3 offset:28160
  ds_read_b128 v[68:71], v3 offset:28800
  s_mov_b64 exec, -1
  v_exp_f32 v11, v11
  v_exp_f32 v12, v12
  v_exp_f32 v13, v13
  s_waitcnt lgkmcnt(2)
  v_mfma_f32_32x32x16_bf16 v[24:39], v[76:79], v[72:75], 0
  v_exp_f32 v14, v14
  v_exp_f32 v15, v15
  v_exp_f32 v16, v16
  v_exp_f32 v17, v17
  v_mfma_f32_32x32x8_bf16 v[24:39], v[82:83], v[80:81], v[24:39]
  s_setprio 0
  ds_read2st64_b64 v[76:79], v2 offset0:60 offset1:61
  v_exp_f32 v18, v18
  s_mov_b64 exec, s[62:63]
  ds_read_b64 v[82:83], v2 offset:31744
  s_mov_b64 exec, -1
  v_exp_f32 v19, v19
  v_exp_f32 v20, v20
  v_exp_f32 v21, v21
  s_waitcnt lgkmcnt(4)
  v_smfmac_f32_32x32x32_bf16 v[40:55], v[56:59], v[8:15], v4
  v_exp_f32 v22, v22
  v_exp_f32 v23, v23
  s_mul_i32 s57, s50, 98304
  s_mul_i32 m0, s44, 12288
  s_add_u32 s53, s44, s50
  s_and_b32 s53, s53, 7
  s_mul_i32 s53, s53, 12288
  s_add_u32 s57, s57, s53
  s_add_u32 s57, s57, 0x780000
  s_barrier
  s_setprio 1
  v_exp_f32 v24, v24
  v_exp_f32 v25, v25
  v_smfmac_f32_32x32x32_bf16 v[40:55], v[60:63], v[16:23], v4
  v_exp_f32 v26, v26
  s_mov_b64 exec, s[60:61]
  ds_read_b128 v[56:59], v3 offset:30720
  ds_read_b128 v[60:63], v3 offset:31360
  s_mov_b64 exec, -1
  v_exp_f32 v27, v27
  v_exp_f32 v28, v28
  v_exp_f32 v29, v29
  s_waitcnt lgkmcnt(2)
  v_mfma_f32_32x32x16_bf16 v[8:23], v[76:79], v[72:75], 0
  v_exp_f32 v30, v30
  v_exp_f32 v31, v31
  v_exp_f32 v32, v32
  v_exp_f32 v33, v33
  v_mfma_f32_32x32x8_bf16 v[8:23], v[82:83], v[80:81], v[8:23]
  s_setprio 0
  ds_read2st64_b64 v[76:79], v2 offset0:65 offset1:66
  v_exp_f32 v34, v34
  s_mov_b64 exec, s[62:63]
  ds_read_b64 v[82:83], v2 offset:34304
  s_mov_b64 exec, -1
  v_exp_f32 v35, v35
  v_exp_f32 v36, v36
  v_exp_f32 v37, v37
  s_waitcnt lgkmcnt(4)
  v_smfmac_f32_32x32x32_bf16 v[40:55], v[64:67], v[24:31], v4
  v_exp_f32 v38, v38
  v_exp_f32 v39, v39
  buffer_load_dwordx4 v1, s[24:27], s57 offen sc1 lds
  s_add_u32 m0, m0, 1024
  s_add_u32 s57, s57, 1024
  buffer_load_dwordx4 v[172:175], v1, s[24:27], s58 offen offset:2048 sc1
  s_setprio 1
  v_exp_f32 v8, v8
  v_exp_f32 v9, v9
  v_smfmac_f32_32x32x32_bf16 v[40:55], v[68:71], v[32:39], v4
  v_exp_f32 v10, v10
  s_mov_b64 exec, s[60:61]
  ds_read_b128 v[64:67], v3 offset:33280
  ds_read_b128 v[68:71], v3 offset:33920
  s_mov_b64 exec, -1
  v_exp_f32 v11, v11
  v_exp_f32 v12, v12
  v_exp_f32 v13, v13
  s_waitcnt lgkmcnt(2)
  v_mfma_f32_32x32x16_bf16 v[24:39], v[76:79], v[72:75], 0
  v_exp_f32 v14, v14
  v_exp_f32 v15, v15
  v_exp_f32 v16, v16
  v_exp_f32 v17, v17
  v_mfma_f32_32x32x8_bf16 v[24:39], v[82:83], v[80:81], v[24:39]
  s_setprio 0
  ds_read2st64_b64 v[76:79], v2 offset0:70 offset1:71
  v_exp_f32 v18, v18
  s_mov_b64 exec, s[62:63]
  ds_read_b64 v[82:83], v2 offset:36864
  s_mov_b64 exec, -1
  v_exp_f32 v19, v19
  v_exp_f32 v20, v20
  v_exp_f32 v21, v21
  s_waitcnt lgkmcnt(4)
  v_smfmac_f32_32x32x32_bf16 v[40:55], v[56:59], v[8:15], v4
  v_exp_f32 v22, v22
  v_exp_f32 v23, v23
  buffer_load_dwordx4 v1, s[24:27], s57 offen sc1 lds
  s_add_u32 m0, m0, 1024
  s_add_u32 s57, s57, 1024
  buffer_load_dwordx4 v[176:179], v1, s[24:27], s58 offen offset:3072 sc1
  s_cmp_eq_u32 s96, 2
  s_cselect_b32 s55, s101, 4096
  s_add_u32 s58, s58, s55
  s_cmp_ge_u32 s44, 4
  s_cselect_b32 s58, s97, s58
  s_setprio 1
  v_exp_f32 v24, v24
  v_exp_f32 v25, v25
  v_smfmac_f32_32x32x32_bf16 v[40:55], v[60:63], v[16:23], v4
  v_exp_f32 v26, v26
  s_mov_b64 exec, s[60:61]
  ds_read_b128 v[56:59], v3 offset:35840
  ds_read_b128 v[60:63], v3 offset:36480
  s_mov_b64 exec, -1
  v_exp_f32 v27, v27
  v_exp_f32 v28, v28
  v_exp_f32 v29, v29
  s_waitcnt lgkmcnt(2)
  v_mfma_f32_32x32x16_bf16 v[8:23], v[76:79], v[72:75], 0
  v_exp_f32 v30, v30
  v_exp_f32 v31, v31
  v_exp_f32 v32, v32
  v_exp_f32 v33, v33
  v_mfma_f32_32x32x8_bf16 v[8:23], v[82:83], v[80:81], v[8:23]
  s_setprio 0
  ds_read2st64_b64 v[76:79], v2 offset0:75 offset1:76
  v_exp_f32 v34, v34
  s_mov_b64 exec, s[62:63]
  ds_read_b64 v[82:83], v2 offset:39424
  s_mov_b64 exec, -1
  v_exp_f32 v35, v35
  v_exp_f32 v36, v36
  v_exp_f32 v37, v37
  s_waitcnt lgkmcnt(4)
  v_smfmac_f32_32x32x32_bf16 v[40:55], v[64:67], v[24:31], v4
  v_exp_f32 v38, v38
  v_exp_f32 v39, v39
  buffer_load_dwordx4 v1, s[24:27], s57 offen sc1 lds
  s_add_u32 m0, m0, 1024
  s_add_u32 s57, s57, 1024
  buffer_load_dwordx4 v[180:183], v1, s[24:27], s58 offen offset:0 sc1
  s_setprio 1
  v_exp_f32 v8, v8
  v_exp_f32 v9, v9
  v_smfmac_f32_32x32x32_bf16 v[40:55], v[68:71], v[32:39], v4
  v_exp_f32 v10, v10
  s_mov_b64 exec, s[60:61]
  ds_read_b128 v[64:67], v3 offset:38400
  ds_read_b128 v[68:71], v3 offset:39040
  s_mov_b64 exec, -1
  v_exp_f32 v11, v11
  v_exp_f32 v12, v12
  v_exp_f32 v13, v13
  s_waitcnt lgkmcnt(2)
  v_mfma_f32_32x32x16_bf16 v[24:39], v[76:79], v[72:75], 0
  v_exp_f32 v14, v14
  v_exp_f32 v15, v15
  v_exp_f32 v16, v16
  v_exp_f32 v17, v17
  v_mfma_f32_32x32x8_bf16 v[24:39], v[82:83], v[80:81], v[24:39]
  s_setprio 0
  ds_read2st64_b64 v[76:79], v2 offset0:80 offset1:81
  v_exp_f32 v18, v18
  s_mov_b64 exec, s[62:63]
  ds_read_b64 v[82:83], v2 offset:41984
  s_mov_b64 exec, -1
  v_exp_f32 v19, v19
  v_exp_f32 v20, v20
  v_exp_f32 v21, v21
  s_waitcnt lgkmcnt(4)
  v_smfmac_f32_32x32x32_bf16 v[40:55], v[56:59], v[8:15], v4
  v_exp_f32 v22, v22
  v_exp_f32 v23, v23
  buffer_load_dwordx4 v1, s[24:27], s57 offen sc1 lds
  s_add_u32 m0, m0, 1024
  s_add_u32 s57, s57, 1024
  buffer_load_dwordx4 v[184:187], v1, s[24:27], s58 offen offset:1024 sc1
  s_setprio 1
  v_exp_f32 v24, v24
  v_exp_f32 v25, v25
  v_smfmac_f32_32x32x32_bf16 v[40:55], v[60:63], v[16:23], v4
  v_exp_f32 v26, v26
  s_mov_b64 exec, s[60:61]
  ds_read_b128 v[56:59], v3 offset:40960
  ds_read_b128 v[60:63], v3 offset:41600
  s_mov_b64 exec, -1
  v_exp_f32 v27, v27
  v_exp_f32 v28, v28
  v_exp_f32 v29, v29
  s_waitcnt lgkmcnt(2)
  v_mfma_f32_32x32x16_bf16 v[8:23], v[76:79], v[72:75], 0
  v_exp_f32 v30, v30
  v_exp_f32 v31, v31
  v_exp_f32 v32, v32
  v_exp_f32 v33, v33
  v_mfma_f32_32x32x8_bf16 v[8:23], v[82:83], v[80:81], v[8:23]
  s_setprio 0
  ds_read2st64_b64 v[76:79], v2 offset0:85 offset1:86
  v_exp_f32 v34, v34
  s_mov_b64 exec, s[62:63]
  ds_read_b64 v[82:83], v2 offset:44544
  s_mov_b64 exec, -1
  v_exp_f32 v35, v35
  v_exp_f32 v36, v36
  v_exp_f32 v37, v37
  s_waitcnt lgkmcnt(4)
  v_smfmac_f32_32x32x32_bf16 v[40:55], v[64:67], v[24:31], v4
  v_exp_f32 v38, v38
  v_exp_f32 v39, v39
  buffer_load_dwordx4 v1, s[24:27], s57 offen sc1 lds
  s_add_u32 m0, m0, 1024
  s_add_u32 s57, s57, 1024
  buffer_load_dwordx4 v[188:191], v1, s[24:27], s58 offen offset:2048 sc1
  v_add_u32 v2, 40960, v2
  v_add_u32 v3, 40960, v3
  s_setprio 1
  v_exp_f32 v8, v8
  v_exp_f32 v9, v9
  v_smfmac_f32_32x32x32_bf16 v[40:55], v[68:71], v[32:39], v4
  v_exp_f32 v10, v10
  s_mov_b64 exec, s[60:61]
  ds_read_b128 v[64:67], v3 offset:2560
  ds_read_b128 v[68:71], v3 offset:3200
  s_mov_b64 exec, -1
  v_exp_f32 v11, v11
  v_exp_f32 v12, v12
  v_exp_f32 v13, v13
  s_waitcnt lgkmcnt(2)
  v_mfma_f32_32x32x16_bf16 v[24:39], v[76:79], v[72:75], 0
  v_exp_f32 v14, v14
  v_exp_f32 v15, v15
  v_exp_f32 v16, v16
  v_exp_f32 v17, v17
  v_mfma_f32_32x32x8_bf16 v[24:39], v[82:83], v[80:81], v[24:39]
  s_setprio 0
  ds_read2st64_b64 v[76:79], v2 offset0:10 offset1:11
  v_exp_f32 v18, v18
  s_mov_b64 exec, s[62:63]
  ds_read_b64 v[82:83], v2 offset:6144
  s_mov_b64 exec, -1
  v_exp_f32 v19, v19
  v_exp_f32 v20, v20
  v_exp_f32 v21, v21
  s_waitcnt lgkmcnt(4)
  v_smfmac_f32_32x32x32_bf16 v[40:55], v[56:59], v[8:15], v4
  v_exp_f32 v22, v22
  v_exp_f32 v23, v23
  s_lshl_b32 s52, s50, 8
  s_add_u32 s16, s52, 0x12d0000
  s_mov_b64 exec, 1
  buffer_load_dword v7, off, s[24:27], s16 sc1
  s_mov_b64 exec, -1
  buffer_load_dwordx4 v1, s[24:27], s57 offen sc1 lds
  s_add_u32 m0, m0, 1024
  s_add_u32 s57, s57, 1024
  buffer_load_dwordx4 v[192:195], v1, s[24:27], s58 offen offset:3072 sc1
  s_add_u32 s58, s58, 4096
  s_setprio 1
  v_exp_f32 v24, v24
  v_exp_f32 v25, v25
  v_smfmac_f32_32x32x32_bf16 v[40:55], v[60:63], v[16:23], v4
  v_exp_f32 v26, v26
  s_mov_b64 exec, s[60:61]
  ds_read_b128 v[56:59], v3 offset:5120
  ds_read_b128 v[60:63], v3 offset:5760
  s_mov_b64 exec, -1
  v_exp_f32 v27, v27
  v_exp_f32 v28, v28
  v_exp_f32 v29, v29
  s_waitcnt lgkmcnt(2)
  v_mfma_f32_32x32x16_bf16 v[8:23], v[76:79], v[72:75], 0
  v_exp_f32 v30, v30
  v_exp_f32 v31, v31
  v_exp_f32 v32, v32
  v_exp_f32 v33, v33
  v_mfma_f32_32x32x8_bf16 v[8:23], v[82:83], v[80:81], v[8:23]
  s_setprio 0
  ds_read2st64_b64 v[76:79], v2 offset0:15 offset1:16
  v_exp_f32 v34, v34
  s_mov_b64 exec, s[62:63]
  ds_read_b64 v[82:83], v2 offset:8704
  s_mov_b64 exec, -1
  v_exp_f32 v35, v35
  v_exp_f32 v36, v36
  v_exp_f32 v37, v37
  s_waitcnt lgkmcnt(4)
  v_smfmac_f32_32x32x32_bf16 v[40:55], v[64:67], v[24:31], v4
  v_exp_f32 v38, v38
  v_exp_f32 v39, v39
  buffer_load_dwordx4 v1, s[24:27], s57 offen sc1 lds
  s_add_u32 m0, m0, 1024
  s_add_u32 s57, s57, 1024
  buffer_load_dwordx4 v[196:199], v1, s[24:27], s58 offen offset:0 sc1
  s_setprio 1
  v_exp_f32 v8, v8
  v_exp_f32 v9, v9
  v_smfmac_f32_32x32x32_bf16 v[40:55], v[68:71], v[32:39], v4
  v_exp_f32 v10, v10
  s_mov_b64 exec, s[60:61]
  ds_read_b128 v[64:67], v3 offset:7680
  ds_read_b128 v[68:71], v3 offset:8320
  s_mov_b64 exec, -1
  v_exp_f32 v11, v11
  v_exp_f32 v12, v12
  v_exp_f32 v13, v13
  s_waitcnt lgkmcnt(2)
  v_mfma_f32_32x32x16_bf16 v[24:39], v[76:79], v[72:75], 0
  v_exp_f32 v14, v14
  v_exp_f32 v15, v15
  v_exp_f32 v16, v16
  v_exp_f32 v17, v17
  v_mfma_f32_32x32x8_bf16 v[24:39], v[82:83], v[80:81], v[24:39]
  s_setprio 0
  ds_read2st64_b64 v[76:79], v2 offset0:20 offset1:21
  v_exp_f32 v18, v18
  s_mov_b64 exec, s[62:63]
  ds_read_b64 v[82:83], v2 offset:11264
  s_mov_b64 exec, -1
  v_exp_f32 v19, v19
  v_exp_f32 v20, v20
  v_exp_f32 v21, v21
  s_waitcnt lgkmcnt(4)
  v_smfmac_f32_32x32x32_bf16 v[40:55], v[56:59], v[8:15], v4
  v_exp_f32 v22, v22
  v_exp_f32 v23, v23
  buffer_load_dwordx4 v1, s[24:27], s57 offen sc1 lds
  s_add_u32 m0, m0, 1024
  s_add_u32 s57, s57, 1024
  buffer_load_dwordx4 v[200:203], v1, s[24:27], s58 offen offset:1024 sc1
  s_setprio 1
  v_exp_f32 v24, v24
  v_exp_f32 v25, v25
  v_smfmac_f32_32x32x32_bf16 v[40:55], v[60:63], v[16:23], v4
  v_exp_f32 v26, v26
  s_mov_b64 exec, s[60:61]
  ds_read_b128 v[56:59], v3 offset:10240
  ds_read_b128 v[60:63], v3 offset:10880
  s_mov_b64 exec, -1
  v_exp_f32 v27, v27
  v_exp_f32 v28, v28
  v_exp_f32 v29, v29
  s_waitcnt lgkmcnt(2)
  v_mfma_f32_32x32x16_bf16 v[8:23], v[76:79], v[72:75], 0
  v_exp_f32 v30, v30
  v_exp_f32 v31, v31
  v_exp_f32 v32, v32
  v_exp_f32 v33, v33
  v_mfma_f32_32x32x8_bf16 v[8:23], v[82:83], v[80:81], v[8:23]
  s_setprio 0
  ds_read2st64_b64 v[76:79], v2 offset0:25 offset1:26
  v_exp_f32 v34, v34
  s_mov_b64 exec, s[62:63]
  ds_read_b64 v[82:83], v2 offset:13824
  s_mov_b64 exec, -1
  v_exp_f32 v35, v35
  v_exp_f32 v36, v36
  v_exp_f32 v37, v37
  s_waitcnt lgkmcnt(4)
  v_smfmac_f32_32x32x32_bf16 v[40:55], v[64:67], v[24:31], v4
  v_exp_f32 v38, v38
  v_exp_f32 v39, v39
  buffer_load_dwordx4 v1, s[24:27], s57 offen sc1 lds
  s_add_u32 m0, m0, 1024
  s_add_u32 s57, s57, 1024
  buffer_load_dwordx4 v[204:207], v1, s[24:27], s58 offen offset:2048 sc1
  s_setprio 1
  v_exp_f32 v8, v8
  v_exp_f32 v9, v9
  v_smfmac_f32_32x32x32_bf16 v[40:55], v[68:71], v[32:39], v4
  v_exp_f32 v10, v10
  s_mov_b64 exec, s[60:61]
  ds_read_b128 v[64:67], v3 offset:12800
  ds_read_b128 v[68:71], v3 offset:13440
  s_mov_b64 exec, -1
  v_exp_f32 v11, v11
  v_exp_f32 v12, v12
  v_exp_f32 v13, v13
  s_waitcnt lgkmcnt(2)
  v_mfma_f32_32x32x16_bf16 v[24:39], v[76:79], v[72:75], 0
  v_exp_f32 v14, v14
  v_exp_f32 v15, v15
  v_exp_f32 v16, v16
  v_exp_f32 v17, v17
  v_mfma_f32_32x32x8_bf16 v[24:39], v[82:83], v[80:81], v[24:39]
  s_setprio 0
  ds_read2st64_b64 v[76:79], v2 offset0:30 offset1:31
  v_exp_f32 v18, v18
  s_mov_b64 exec, s[62:63]
  ds_read_b64 v[82:83], v2 offset:16384
  s_mov_b64 exec, -1
  v_exp_f32 v19, v19
  v_exp_f32 v20, v20
  v_exp_f32 v21, v21
  s_waitcnt lgkmcnt(4)
  v_smfmac_f32_32x32x32_bf16 v[40:55], v[56:59], v[8:15], v4
  v_exp_f32 v22, v22
  v_exp_f32 v23, v23
  buffer_load_dwordx4 v1, s[24:27], s57 offen sc1 lds
  s_add_u32 m0, m0, 1024
  s_add_u32 s57, s57, 1024
  buffer_load_dwordx4 v[208:211], v1, s[24:27], s58 offen offset:3072 sc1
  s_add_u32 s58, s58, 4096
  s_cmp_ge_u32 s44, 4
  s_cselect_b32 s58, s98, s58
  s_setprio 1
  v_exp_f32 v24, v24
  v_exp_f32 v25, v25
  v_smfmac_f32_32x32x32_bf16 v[40:55], v[60:63], v[16:23], v4
  v_exp_f32 v26, v26
  s_mov_b64 exec, s[60:61]
  ds_read_b128 v[56:59], v3 offset:15360
  ds_read_b128 v[60:63], v3 offset:16000
  s_mov_b64 exec, -1
  v_exp_f32 v27, v27
  v_exp_f32 v28, v28
  v_exp_f32 v29, v29
  s_waitcnt lgkmcnt(2)
  v_mfma_f32_32x32x16_bf16 v[8:23], v[76:79], v[72:75], 0
  v_exp_f32 v30, v30
  v_exp_f32 v31, v31
  v_exp_f32 v32, v32
  v_exp_f32 v33, v33
  v_mfma_f32_32x32x8_bf16 v[8:23], v[82:83], v[80:81], v[8:23]
  s_setprio 0
  ds_read2st64_b64 v[76:79], v2 offset0:35 offset1:36
  v_exp_f32 v34, v34
  s_mov_b64 exec, s[62:63]
  ds_read_b64 v[82:83], v2 offset:18944
  s_mov_b64 exec, -1
  v_exp_f32 v35, v35
  v_exp_f32 v36, v36
  v_exp_f32 v37, v37
  s_waitcnt lgkmcnt(4)
  v_smfmac_f32_32x32x32_bf16 v[40:55], v[64:67], v[24:31], v4
  v_exp_f32 v38, v38
  v_exp_f32 v39, v39
  buffer_load_dwordx4 v1, s[24:27], s57 offen sc1 lds
  s_add_u32 m0, m0, 1024
  s_add_u32 s57, s57, 1024
  buffer_load_dwordx4 v[212:215], v1, s[24:27], s58 offen offset:0 sc1
  s_setprio 1
  v_exp_f32 v8, v8
  v_exp_f32 v9, v9
  v_smfmac_f32_32x32x32_bf16 v[40:55], v[68:71], v[32:39], v4
  v_exp_f32 v10, v10
  s_mov_b64 exec, s[60:61]
  ds_read_b128 v[64:67], v3 offset:17920
  ds_read_b128 v[68:71], v3 offset:18560
  s_mov_b64 exec, -1
  v_exp_f32 v11, v11
  v_exp_f32 v12, v12
  v_exp_f32 v13, v13
  s_waitcnt lgkmcnt(2)
  v_mfma_f32_32x32x16_bf16 v[24:39], v[76:79], v[72:75], 0
  v_exp_f32 v14, v14
  v_exp_f32 v15, v15
  v_exp_f32 v16, v16
  v_exp_f32 v17, v17
  v_mfma_f32_32x32x8_bf16 v[24:39], v[82:83], v[80:81], v[24:39]
  s_setprio 0
  ds_read2st64_b64 v[76:79], v2 offset0:40 offset1:41
  v_exp_f32 v18, v18
  s_mov_b64 exec, s[62:63]
  ds_read_b64 v[82:83], v2 offset:21504
  s_mov_b64 exec, -1
  v_exp_f32 v19, v19
  v_exp_f32 v20, v20
  v_exp_f32 v21, v21
  s_waitcnt lgkmcnt(4)
  v_smfmac_f32_32x32x32_bf16 v[40:55], v[56:59], v[8:15], v4
  v_exp_f32 v22, v22
  v_exp_f32 v23, v23
  buffer_load_dwordx4 v1, s[24:27], s57 offen sc1 lds
  s_add_u32 m0, m0, 1024
  s_add_u32 s57, s57, 1024
  buffer_load_dwordx4 v[216:219], v1, s[24:27], s58 offen offset:1024 sc1
  s_cmp_ge_u32 s44, 4
  s_cselect_b32 s58, s99, s58
  s_cselect_b32 s96, 0, s96
  s_setprio 1
  v_exp_f32 v24, v24
  v_exp_f32 v25, v25
  v_smfmac_f32_32x32x32_bf16 v[40:55], v[60:63], v[16:23], v4
  v_exp_f32 v26, v26
  s_mov_b64 exec, s[60:61]
  ds_read_b128 v[56:59], v3 offset:20480
  ds_read_b128 v[60:63], v3 offset:21120
  s_mov_b64 exec, -1
  v_exp_f32 v27, v27
  v_exp_f32 v28, v28
  v_exp_f32 v29, v29
  s_waitcnt lgkmcnt(2)
  v_mfma_f32_32x32x16_bf16 v[8:23], v[76:79], v[72:75], 0
  v_exp_f32 v30, v30
  v_exp_f32 v31, v31
  v_exp_f32 v32, v32
  v_exp_f32 v33, v33
  v_mfma_f32_32x32x8_bf16 v[8:23], v[82:83], v[80:81], v[8:23]
  s_setprio 0
  ds_read2st64_b64 v[76:79], v2 offset0:45 offset1:46
  v_exp_f32 v34, v34
  s_mov_b64 exec, s[62:63]
  ds_read_b64 v[82:83], v2 offset:24064
  s_mov_b64 exec, -1
  v_exp_f32 v35, v35
  v_exp_f32 v36, v36
  v_exp_f32 v37, v37
  s_waitcnt lgkmcnt(4)
  v_smfmac_f32_32x32x32_bf16 v[40:55], v[64:67], v[24:31], v4
  v_exp_f32 v38, v38
  v_exp_f32 v39, v39
  buffer_load_dwordx4 v[220:223], v1, s[24:27], s58 offen offset:2048 sc1
  buffer_load_dwordx4 v[224:227], v1, s[24:27], s58 offen offset:3072 sc1
  s_cmp_eq_u32 s96, 3
  s_cselect_b32 s55, s101, 4096
  s_add_u32 s58, s58, s55
  buffer_load_dwordx4 v[228:231], v1, s[24:27], s58 offen offset:0 sc1
  s_setprio 1
  v_exp_f32 v8, v8
  v_exp_f32 v9, v9
  v_smfmac_f32_32x32x32_bf16 v[40:55], v[68:71], v[32:39], v4
  v_exp_f32 v10, v10
  s_mov_b64 exec, s[60:61]
  ds_read_b128 v[64:67], v3 offset:23040
  ds_read_b128 v[68:71], v3 offset:23680
  s_mov_b64 exec, -1
  v_exp_f32 v11, v11
  v_exp_f32 v12, v12
  v_exp_f32 v13, v13
  s_waitcnt lgkmcnt(2)
  v_mfma_f32_32x32x16_bf16 v[24:39], v[76:79], v[72:75], 0
  v_exp_f32 v14, v14
  v_exp_f32 v15, v15
  v_exp_f32 v16, v16
  v_exp_f32 v17, v17
  v_mfma_f32_32x32x8_bf16 v[24:39], v[82:83], v[80:81], v[24:39]
  s_setprio 0
  ds_read2st64_b64 v[76:79], v2 offset0:50 offset1:51
  v_exp_f32 v18, v18
  s_mov_b64 exec, s[62:63]
  ds_read_b64 v[82:83], v2 offset:26624
  s_mov_b64 exec, -1
  v_exp_f32 v19, v19
  v_exp_f32 v20, v20
  v_exp_f32 v21, v21
  s_waitcnt lgkmcnt(4)
  v_smfmac_f32_32x32x32_bf16 v[40:55], v[56:59], v[8:15], v4
  v_exp_f32 v22, v22
  v_exp_f32 v23, v23
  buffer_load_dwordx4 v[232:235], v1, s[24:27], s58 offen offset:1024 sc1
  buffer_load_dwordx4 v[236:239], v1, s[24:27], s58 offen offset:2048 sc1
  buffer_load_dwordx4 v[240:243], v1, s[24:27], s58 offen offset:3072 sc1
  s_add_u32 s58, s58, 4096
  s_setprio 1
  v_exp_f32 v24, v24
  v_exp_f32 v25, v25
  v_smfmac_f32_32x32x32_bf16 v[40:55], v[60:63], v[16:23], v4
  v_exp_f32 v26, v26
  s_mov_b64 exec, s[60:61]
  ds_read_b128 v[56:59], v3 offset:25600
  ds_read_b128 v[60:63], v3 offset:26240
  s_mov_b64 exec, -1
  v_exp_f32 v27, v27
  v_exp_f32 v28, v28
  v_exp_f32 v29, v29
  s_waitcnt lgkmcnt(2)
  v_mfma_f32_32x32x16_bf16 v[8:23], v[76:79], v[72:75], 0
  v_exp_f32 v30, v30
  v_exp_f32 v31, v31
  v_exp_f32 v32, v32
  v_exp_f32 v33, v33
  v_mfma_f32_32x32x8_bf16 v[8:23], v[82:83], v[80:81], v[8:23]
  s_setprio 0
  ds_read2st64_b64 v[76:79], v2 offset0:55 offset1:56
  v_exp_f32 v34, v34
  s_mov_b64 exec, s[62:63]
  ds_read_b64 v[82:83], v2 offset:29184
  s_mov_b64 exec, -1
  v_exp_f32 v35, v35
  v_exp_f32 v36, v36
  v_exp_f32 v37, v37
  s_waitcnt lgkmcnt(4)
  v_smfmac_f32_32x32x32_bf16 v[40:55], v[64:67], v[24:31], v4
  v_exp_f32 v38, v38
  v_exp_f32 v39, v39
  buffer_load_dwordx4 v[244:247], v1, s[24:27], s58 offen offset:0 sc1
  buffer_load_dwordx4 v[248:251], v1, s[24:27], s58 offen offset:1024 sc1
  buffer_load_dwordx4 v[252:255], v1, s[24:27], s58 offen offset:2048 sc1
  s_setprio 1
  v_exp_f32 v8, v8
  v_exp_f32 v9, v9
  v_smfmac_f32_32x32x32_bf16 v[40:55], v[68:71], v[32:39], v4
  v_exp_f32 v10, v10
  s_mov_b64 exec, s[60:61]
  ds_read_b128 v[64:67], v3 offset:28160
  ds_read_b128 v[68:71], v3 offset:28800
  s_mov_b64 exec, -1
  v_exp_f32 v11, v11
  v_exp_f32 v12, v12
  v_exp_f32 v13, v13
  s_waitcnt lgkmcnt(2)
  v_mfma_f32_32x32x16_bf16 v[24:39], v[76:79], v[72:75], 0
  v_exp_f32 v14, v14
  v_exp_f32 v15, v15
  v_exp_f32 v16, v16
  v_exp_f32 v17, v17
  v_mfma_f32_32x32x8_bf16 v[24:39], v[82:83], v[80:81], v[24:39]
  s_setprio 0
  ds_read2st64_b64 v[76:79], v2 offset0:60 offset1:61
  v_exp_f32 v18, v18
  s_mov_b64 exec, s[62:63]
  ds_read_b64 v[82:83], v2 offset:31744
  s_mov_b64 exec, -1
  v_exp_f32 v19, v19
  v_exp_f32 v20, v20
  v_exp_f32 v21, v21
  s_waitcnt lgkmcnt(4)
  v_smfmac_f32_32x32x32_bf16 v[40:55], v[56:59], v[8:15], v4
  v_exp_f32 v22, v22
  v_exp_f32 v23, v23
  s_mul_i32 s52, s44, 9216
  s_mul_i32 s53, s44, 3072
  s_add_u32 s53, s53, 24576
  s_min_u32 s52, s52, s53
  s_add_u32 m0, s52, 98304
  s_waitcnt vmcnt(10)
  v_readfirstlane_b32 s53, v7
  s_cmp_lt_u32 s53, 32
  s_cbranch_scc1 L_c_spin
L_c_ok:
  s_barrier
  s_setprio 1
  v_exp_f32 v24, v24
  v_exp_f32 v25, v25
  v_smfmac_f32_32x32x32_bf16 v[40:55], v[60:63], v[16:23], v4
  v_exp_f32 v26, v26
  s_mov_b64 exec, s[60:61]
  ds_read_b128 v[56:59], v3 offset:30720
  ds_read_b128 v[60:63], v3 offset:31360
  s_mov_b64 exec, -1
  v_exp_f32 v27, v27
  v_exp_f32 v28, v28
  v_exp_f32 v29, v29
  s_waitcnt lgkmcnt(2)
  v_mfma_f32_32x32x16_bf16 v[8:23], v[76:79], v[72:75], 0
  v_exp_f32 v30, v30
  v_exp_f32 v31, v31
  v_exp_f32 v32, v32
  v_exp_f32 v33, v33
  v_mfma_f32_32x32x8_bf16 v[8:23], v[82:83], v[80:81], v[8:23]
  s_setprio 0
  ds_read2st64_b64 v[76:79], v2 offset0:65 offset1:66
  v_exp_f32 v34, v34
  s_mov_b64 exec, s[62:63]
  ds_read_b64 v[82:83], v2 offset:34304
  s_mov_b64 exec, -1
  v_exp_f32 v35, v35
  v_exp_f32 v36, v36
  v_exp_f32 v37, v37
  s_waitcnt lgkmcnt(4)
  v_smfmac_f32_32x32x32_bf16 v[40:55], v[64:67], v[24:31], v4
  v_exp_f32 v38, v38
  v_exp_f32 v39, v39
  s_add_u32 s55, s58, 3072
  buffer_load_dwordx4 v1, s[24:27], s55 offen sc1 lds
  s_add_u32 m0, m0, 1024
  s_add_u32 s58, s58, 4096
  s_add_u32 s55, s58, 0
  buffer_load_dwordx4 v1, s[24:27], s55 offen sc1 lds
  s_add_u32 m0, m0, 1024
  s_add_u32 s55, s58, 1024
  buffer_load_dwordx4 v1, s[24:27], s55 offen sc1 lds
  s_add_u32 m0, m0, 1024
  s_setprio 1
  v_exp_f32 v8, v8
  v_exp_f32 v9, v9
  v_smfmac_f32_32x32x32_bf16 v[40:55], v[68:71], v[32:39], v4
  v_exp_f32 v10, v10
  s_mov_b64 exec, s[60:61]
  ds_read_b128 v[64:67], v3 offset:33280
  ds_read_b128 v[68:71], v3 offset:33920
  s_mov_b64 exec, -1
  v_exp_f32 v11, v11
  v_exp_f32 v12, v12
  v_exp_f32 v13, v13
  s_waitcnt lgkmcnt(2)
  v_mfma_f32_32x32x16_bf16 v[24:39], v[76:79], v[72:75], 0
  v_exp_f32 v14, v14
  v_exp_f32 v15, v15
  v_exp_f32 v16, v16
  v_exp_f32 v17, v17
  v_mfma_f32_32x32x8_bf16 v[24:39], v[82:83], v[80:81], v[24:39]
  s_setprio 0
  ds_read2st64_b64 v[76:79], v2 offset0:70 offset1:71
  v_exp_f32 v18, v18
  s_mov_b64 exec, s[62:63]
  ds_read_b64 v[82:83], v2 offset:36864
  s_mov_b64 exec, -1
  v_exp_f32 v19, v19
  v_exp_f32 v20, v20
  v_exp_f32 v21, v21
  s_waitcnt lgkmcnt(4)
  v_smfmac_f32_32x32x32_bf16 v[40:55], v[56:59], v[8:15], v4
  v_exp_f32 v22, v22
  v_exp_f32 v23, v23
  s_cmp_ge_u32 s44, 4
  s_cbranch_scc1 L_nst3
  s_add_u32 s55, s58, 2048
  buffer_load_dwordx4 v1, s[24:27], s55 offen sc1 lds
  s_add_u32 m0, m0, 1024
  s_add_u32 s55, s58, 3072
  buffer_load_dwordx4 v1, s[24:27], s55 offen sc1 lds
  s_add_u32 m0, m0, 1024
  s_cmp_eq_u32 s96, 4
  s_cselect_b32 s55, s101, 4096
  s_add_u32 s58, s58, s55
  s_add_u32 s55, s58, 0
  buffer_load_dwordx4 v1, s[24:27], s55 offen sc1 lds
  s_add_u32 m0, m0, 1024
L_nst3:
  s_setprio 1
  v_exp_f32 v24, v24
  v_exp_f32 v25, v25
  v_smfmac_f32_32x32x32_bf16 v[40:55], v[60:63], v[16:23], v4
  v_exp_f32 v26, v26
  s_mov_b64 exec, s[60:61]
  ds_read_b128 v[56:59], v3 offset:35840
  ds_read_b128 v[60:63], v3 offset:36480
  s_mov_b64 exec, -1
  v_exp_f32 v27, v27
  v_exp_f32 v28, v28
  v_exp_f32 v29, v29
  s_waitcnt lgkmcnt(2)
  v_mfma_f32_32x32x16_bf16 v[8:23], v[76:79], v[72:75], 0
  v_exp_f32 v30, v30
  v_exp_f32 v31, v31
  v_exp_f32 v32, v32
  v_exp_f32 v33, v33
  v_mfma_f32_32x32x8_bf16 v[8:23], v[82:83], v[80:81], v[8:23]
  s_setprio 0
  ds_read2st64_b64 v[76:79], v2 offset0:75 offset1:76
  v_exp_f32 v34, v34
  s_mov_b64 exec, s[62:63]
  ds_read_b64 v[82:83], v2 offset:39424
  s_mov_b64 exec, -1
  v_exp_f32 v35, v35
  v_exp_f32 v36, v36
  v_exp_f32 v37, v37
  s_waitcnt lgkmcnt(4)
  v_smfmac_f32_32x32x32_bf16 v[40:55], v[64:67], v[24:31], v4
  v_exp_f32 v38, v38
  v_exp_f32 v39, v39
  s_cmp_ge_u32 s44, 4
  s_cbranch_scc1 L_nst6
  s_add_u32 s55, s58, 1024
  buffer_load_dwordx4 v1, s[24:27], s55 offen sc1 lds
  s_add_u32 m0, m0, 1024
  s_add_u32 s55, s58, 2048
  buffer_load_dwordx4 v1, s[24:27], s55 offen sc1 lds
  s_add_u32 m0, m0, 1024
  s_add_u32 s55, s58, 3072
  buffer_load_dwordx4 v1, s[24:27], s55 offen sc1 lds
  s_add_u32 m0, m0, 1024
  s_add_u32 s58, s58, 4096
L_nst6:
  s_setprio 1
  v_exp_f32 v8, v8
  v_exp_f32 v9, v9
  v_smfmac_f32_32x32x32_bf16 v[40:55], v[68:71], v[32:39], v4
  v_exp_f32 v10, v10
  s_mov_b64 exec, s[60:61]
  ds_read_b128 v[64:67], v3 offset:38400
  ds_read_b128 v[68:71], v3 offset:39040
  s_mov_b64 exec, -1
  v_exp_f32 v11, v11
  v_exp_f32 v12, v12
  v_exp_f32 v13, v13
  s_waitcnt lgkmcnt(2)
  v_mfma_f32_32x32x16_bf16 v[24:39], v[76:79], v[72:75], 0
  v_exp_f32 v14, v14
  v_exp_f32 v15, v15
  v_exp_f32 v16, v16
  v_exp_f32 v17, v17
  v_mfma_f32_32x32x8_bf16 v[24:39], v[82:83], v[80:81], v[24:39]
  s_setprio 0
  v_exp_f32 v18, v18
  v_exp_f32 v19, v19
  v_exp_f32 v20, v20
  v_exp_f32 v21, v21
  s_waitcnt lgkmcnt(2)
  v_smfmac_f32_32x32x32_bf16 v[40:55], v[56:59], v[8:15], v4
  v_exp_f32 v22, v22
  v_exp_f32 v23, v23
  s_nop 0
  s_nop 0
  s_setprio 1
  v_exp_f32 v24, v24
  v_exp_f32 v25, v25
  v_smfmac_f32_32x32x32_bf16 v[40:55], v[60:63], v[16:23], v4
  v_exp_f32 v26, v26
  v_exp_f32 v27, v27
  v_exp_f32 v28, v28
  v_exp_f32 v29, v29
  v_exp_f32 v30, v30
  v_exp_f32 v31, v31
  v_exp_f32 v32, v32
  v_exp_f32 v33, v33
  s_setprio 0
  v_exp_f32 v34, v34
  v_exp_f32 v35, v35
  v_exp_f32 v36, v36
  v_exp_f32 v37, v37
  s_waitcnt lgkmcnt(0)
  v_smfmac_f32_32x32x32_bf16 v[40:55], v[64:67], v[24:31], v4
  v_exp_f32 v38, v38
  v_exp_f32 v39, v39
  s_nop 0
  s_nop 0
  v_smfmac_f32_32x32x32_bf16 v[40:55], v[68:71], v[32:39], v4
  s_cmp_lt_u32 s44, 4
  s_cbranch_scc1 L_lowp
  s_setprio 1
L_lowp:
  v_and_b32 v8, 31, v0
  v_lshrrev_b32 v9, 1, v8
  v_and_b32 v10, 1, v8
  v_lshl_add_u32 v9, v10, 4, v9
  v_lshlrev_b32 v11, 3, v9
  v_lshlrev_b32 v9, 4, v9
  v_lshrrev_b32 v10, 5, v0
  v_lshl_add_u32 v10, v10, 9, v9
  s_nop 7
  v_cndmask_b32 v12, v48, v52, s[62:63]
  v_cmp_nlt_f32 vcc, 0x5d800000, v12
  v_cmp_lt_f32 s[54:55], 0, v12
  v_rcp_f32 v13, v12
  s_and_b64 vcc, vcc, s[54:55]
  s_cmp_eq_u64 vcc, -1
  s_cbranch_scc0 L_slow
L_store:
  s_cmp_ge_u32 s44, 4
  s_cbranch_scc1 L_noearly
L_noearly:
  v_mul_f32 v12, v13, v5
  v_pk_mul_f32 v[40:41], v[40:41], v[12:13] op_sel_hi:[1,0]
  v_pk_mul_f32 v[42:43], v[42:43], v[12:13] op_sel_hi:[1,0]
  v_pk_mul_f32 v[44:45], v[44:45], v[12:13] op_sel_hi:[1,0]
  v_pk_mul_f32 v[46:47], v[46:47], v[12:13] op_sel_hi:[1,0]
  v_cvt_pk_bf16_f32 v24, v40, v41
  v_cvt_pk_bf16_f32 v25, v42, v43
  v_cvt_pk_bf16_f32 v26, v44, v45
  v_cvt_pk_bf16_f32 v27, v46, v47
  v_min_u32 v24, -2, v24
  v_min_u32 v25, -2, v25
  v_min_u32 v26, -2, v26
  v_min_u32 v27, -2, v27
  buffer_store_dwordx4 v[24:27], v10, s[24:27], s14 offen sc1
  v_pk_mul_f32 v[48:49], v[48:49], v[12:13] op_sel_hi:[1,0]
  v_pk_mul_f32 v[50:51], v[50:51], v[12:13] op_sel_hi:[1,0]
  v_cvt_pk_bf16_f32 v28, v48, v49
  v_cvt_pk_bf16_f32 v29, v50, v51
  v_min_u32 v28, -2, v28
  v_min_u32 v29, -2, v29
  s_mov_b64 exec, s[62:63]
  buffer_store_dwordx2 v[28:29], v11, s[24:27], s15 offen sc1
  s_mov_b64 exec, -1
  v_mov_b32 v2, v1
  v_add_u32 v3, 65536, v1
  v_sub_f32 v6, 1.0, v6
  s_mul_i32 s52, s44, 9216
  s_mul_i32 s53, s44, 3072
  s_add_u32 s53, s53, 24576
  s_min_u32 s52, s52, s53
  s_add_u32 s52, s52, 98304
  v_add_u32 v5, s52, v1
  s_mov_b32 s28, s18
  s_mov_b32 s29, s19
  s_mov_b32 s30, 0x280000
  s_mov_b32 s31, 0x20000
  s_cmp_ge_u32 s44, 4
  s_cbranch_scc1 L_small
  ds_read_b128 v[24:27], v2 offset:0
  ds_read_b128 v[28:31], v2 offset:1024
  ds_read_b128 v[32:35], v2 offset:2048
  buffer_load_dwordx4 v[40:43], v1, s[24:27], s58 offen offset:0 sc1
  buffer_load_dwordx4 v[44:47], v1, s[24:27], s58 offen offset:1024 sc1
  buffer_load_dwordx4 v[48:51], v1, s[24:27], s58 offen offset:2048 sc1
  buffer_load_dwordx4 v[52:55], v1, s[24:27], s58 offen offset:3072 sc1
  s_add_u32 s58, s58, 4096
  ds_read_b128 v[36:39], v2 offset:3072
  s_waitcnt lgkmcnt(3)
  v_mfma_f32_32x32x16_bf16 v[8:23], v[84:87], v[24:27], 0
  buffer_load_dwordx4 v[56:59], v1, s[24:27], s58 offen offset:0 sc1
  ds_read_b128 v[24:27], v2 offset:4096
  s_waitcnt lgkmcnt(3)
  v_mfma_f32_32x32x16_bf16 v[8:23], v[88:91], v[28:31], v[8:23]
  buffer_load_dwordx4 v[60:63], v1, s[24:27], s58 offen offset:1024 sc1
  ds_read_b128 v[28:31], v2 offset:5120
  s_waitcnt lgkmcnt(3)
  v_mfma_f32_32x32x16_bf16 v[8:23], v[92:95], v[32:35], v[8:23]
  buffer_load_dwordx4 v[64:67], v1, s[24:27], s58 offen offset:2048 sc1
  ds_read_b128 v[32:35], v2 offset:6144
  s_waitcnt lgkmcnt(3)
  v_mfma_f32_32x32x16_bf16 v[8:23], v[96:99], v[36:39], v[8:23]
  ds_read_b128 v[36:39], v2 offset:7168
  s_waitcnt lgkmcnt(3)
  v_mfma_f32_32x32x16_bf16 v[8:23], v[100:103], v[24:27], v[8:23]
  buffer_load_dwordx4 v[68:71], v1, s[24:27], s58 offen offset:3072 sc1
  s_cmp_eq_u32 s96, 5
  s_cselect_b32 s55, s101, 4096
  s_add_u32 s58, s58, s55
  ds_read_b128 v[24:27], v2 offset:8192
  s_waitcnt lgkmcnt(3)
  v_mfma_f32_32x32x16_bf16 v[8:23], v[104:107], v[28:31], v[8:23]
  buffer_load_dwordx4 v[72:75], v1, s[24:27], s58 offen offset:0 sc1
  ds_read_b128 v[28:31], v2 offset:9216
  s_waitcnt lgkmcnt(3)
  v_mfma_f32_32x32x16_bf16 v[8:23], v[108:111], v[32:35], v[8:23]
  ds_read_b128 v[32:35], v2 offset:10240
  s_waitcnt lgkmcnt(3)
  v_mfma_f32_32x32x16_bf16 v[8:23], v[112:115], v[36:39], v[8:23]
  buffer_load_dwordx4 v[76:79], v1, s[24:27], s58 offen offset:1024 sc1
  ds_read_b128 v[36:39], v2 offset:11264
  s_waitcnt lgkmcnt(3)
  v_mfma_f32_32x32x16_bf16 v[8:23], v[116:119], v[24:27], v[8:23]
  buffer_load_dwordx4 v[80:83], v1, s[24:27], s58 offen offset:2048 sc1
  ds_read_b128 v[24:27], v2 offset:12288
  s_waitcnt lgkmcnt(3)
  v_mfma_f32_32x32x16_bf16 v[8:23], v[120:123], v[28:31], v[8:23]
  ds_read_b128 v[28:31], v2 offset:13312
  s_waitcnt lgkmcnt(3)
  v_mfma_f32_32x32x16_bf16 v[8:23], v[124:127], v[32:35], v[8:23]
  buffer_load_dwordx4 v[120:123], v1, s[24:27], s58 offen offset:3072 sc1
  s_add_u32 s58, s58, 4096
  ds_read_b128 v[32:35], v2 offset:14336
  s_waitcnt lgkmcnt(3)
  v_mfma_f32_32x32x16_bf16 v[8:23], v[128:131], v[36:39], v[8:23]
  buffer_load_dwordx4 v[124:127], v1, s[24:27], s58 offen offset:0 sc1
  ds_read_b128 v[36:39], v2 offset:15360
  s_waitcnt lgkmcnt(3)
  v_mfma_f32_32x32x16_bf16 v[8:23], v[132:135], v[24:27], v[8:23]
  ds_read_b128 v[24:27], v2 offset:16384
  s_waitcnt lgkmcnt(3)
  v_mfma_f32_32x32x16_bf16 v[8:23], v[136:139], v[28:31], v[8:23]
  buffer_load_dwordx4 v[128:131], v1, s[24:27], s58 offen offset:1024 sc1
  ds_read_b128 v[28:31], v2 offset:17408
  s_waitcnt lgkmcnt(3)
  v_mfma_f32_32x32x16_bf16 v[8:23], v[140:143], v[32:35], v[8:23]
  buffer_load_dwordx4 v[132:135], v1, s[24:27], s58 offen offset:2048 sc1
  ds_read_b128 v[32:35], v2 offset:18432
  s_waitcnt lgkmcnt(3)
  v_mfma_f32_32x32x16_bf16 v[8:23], v[144:147], v[36:39], v[8:23]
  s_waitcnt vmcnt(17)
  ds_read_b128 v[84:87], v5 offset:0
  ds_read_b128 v[36:39], v2 offset:19456
  s_waitcnt lgkmcnt(4)
  v_mfma_f32_32x32x16_bf16 v[8:23], v[148:151], v[24:27], v[8:23]
  buffer_load_dwordx4 v[136:139], v1, s[24:27], s58 offen offset:3072 sc1
  s_add_u32 s58, s58, 4096
  ds_read_b128 v[88:91], v5 offset:1024
  ds_read_b128 v[24:27], v2 offset:20480
  s_waitcnt lgkmcnt(5)
  v_mfma_f32_32x32x16_bf16 v[8:23], v[152:155], v[28:31], v[8:23]
  buffer_load_dwordx4 v[140:143], v1, s[24:27], s58 offen offset:0 sc1
  ds_read_b128 v[92:95], v5 offset:2048
  ds_read_b128 v[28:31], v2 offset:21504
  s_waitcnt lgkmcnt(6)
  v_mfma_f32_32x32x16_bf16 v[8:23], v[156:159], v[32:35], v[8:23]
  ds_read_b128 v[96:99], v5 offset:3072
  ds_read_b128 v[32:35], v2 offset:22528
  s_waitcnt lgkmcnt(6)
  v_mfma_f32_32x32x16_bf16 v[8:23], v[160:163], v[36:39], v[8:23]
  buffer_load_dwordx4 v[144:147], v1, s[24:27], s58 offen offset:1024 sc1
  ds_read_b128 v[100:103], v5 offset:4096
  ds_read_b128 v[36:39], v2 offset:23552
  s_waitcnt lgkmcnt(6)
  v_mfma_f32_32x32x16_bf16 v[8:23], v[164:167], v[24:27], v[8:23]
  buffer_load_dwordx4 v[148:151], v1, s[24:27], s58 offen offset:2048 sc1
  ds_read_b128 v[104:107], v5 offset:5120
  ds_read_b128 v[24:27], v2 offset:24576
  s_waitcnt lgkmcnt(6)
  v_mfma_f32_32x32x16_bf16 v[8:23], v[168:171], v[28:31], v[8:23]
  ds_read_b128 v[108:111], v5 offset:6144
  ds_read_b128 v[28:31], v2 offset:25600
  s_waitcnt lgkmcnt(6)
  v_mfma_f32_32x32x16_bf16 v[8:23], v[172:175], v[32:35], v[8:23]
  buffer_load_dwordx4 v[152:155], v1, s[24:27], s58 offen offset:3072 sc1
  s_cmp_eq_u32 s96, 6
  s_cselect_b32 s55, s101, 4096
  s_add_u32 s58, s58, s55
  ds_read_b128 v[112:115], v5 offset:7168
  ds_read_b128 v[32:35], v2 offset:26624
  s_waitcnt lgkmcnt(6)
  v_mfma_f32_32x32x16_bf16 v[8:23], v[176:179], v[36:39], v[8:23]
  buffer_load_dwordx4 v[156:159], v1, s[24:27], s58 offen offset:0 sc1
  ds_read_b128 v[116:119], v5 offset:8192
  ds_read_b128 v[36:39], v2 offset:27648
  s_waitcnt lgkmcnt(6)
  v_mfma_f32_32x32x16_bf16 v[8:23], v[180:183], v[24:27], v[8:23]
  ds_read_b128 v[24:27], v2 offset:28672
  s_waitcnt lgkmcnt(5)
  v_mfma_f32_32x32x16_bf16 v[8:23], v[184:187], v[28:31], v[8:23]
  buffer_load_dwordx4 v[160:163], v1, s[24:27], s58 offen offset:1024 sc1
  ds_read_b128 v[28:31], v2 offset:29696
  s_waitcnt lgkmcnt(4)
  v_mfma_f32_32x32x16_bf16 v[8:23], v[188:191], v[32:35], v[8:23]
  buffer_load_dwordx4 v[164:167], v1, s[24:27], s58 offen offset:2048 sc1
  ds_read_b128 v[32:35], v2 offset:30720
  s_waitcnt lgkmcnt(3)
  v_mfma_f32_32x32x16_bf16 v[8:23], v[192:195], v[36:39], v[8:23]
  ds_read_b128 v[36:39], v2 offset:31744
  s_waitcnt lgkmcnt(3)
  v_mfma_f32_32x32x16_bf16 v[8:23], v[196:199], v[24:27], v[8:23]
  buffer_load_dwordx4 v[168:171], v1, s[24:27], s58 offen offset:3072 sc1
  s_add_u32 s58, s58, 4096
  ds_read_b128 v[24:27], v2 offset:32768
  s_waitcnt lgkmcnt(3)
  v_mfma_f32_32x32x16_bf16 v[8:23], v[200:203], v[28:31], v[8:23]
  buffer_load_dwordx4 v[172:175], v1, s[24:27], s58 offen offset:0 sc1
  ds_read_b128 v[28:31], v2 offset:33792
  s_waitcnt lgkmcnt(3)
  v_mfma_f32_32x32x16_bf16 v[8:23], v[204:207], v[32:35], v[8:23]
  ds_read_b128 v[32:35], v2 offset:34816
  s_waitcnt lgkmcnt(3)
  v_mfma_f32_32x32x16_bf16 v[8:23], v[208:211], v[36:39], v[8:23]
  buffer_load_dwordx4 v[176:179], v1, s[24:27], s58 offen offset:1024 sc1
  ds_read_b128 v[36:39], v2 offset:35840
  s_waitcnt lgkmcnt(3)
  v_mfma_f32_32x32x16_bf16 v[8:23], v[212:215], v[24:27], v[8:23]
  buffer_load_dwordx4 v[180:183], v1, s[24:27], s58 offen offset:2048 sc1
  s_barrier
  ds_read_b128 v[24:27], v2 offset:36864
  s_waitcnt lgkmcnt(3)
  v_mfma_f32_32x32x16_bf16 v[8:23], v[216:219], v[28:31], v[8:23]
  ds_read_b128 v[28:31], v2 offset:37888
  s_waitcnt lgkmcnt(3)
  v_mfma_f32_32x32x16_bf16 v[8:23], v[220:223], v[32:35], v[8:23]
  buffer_load_dwordx4 v[184:187], v1, s[24:27], s58 offen offset:3072 sc1
  s_add_u32 s58, s58, 4096
  ds_read_b128 v[32:35], v2 offset:38912
  s_waitcnt lgkmcnt(3)
  v_mfma_f32_32x32x16_bf16 v[8:23], v[224:227], v[36:39], v[8:23]
  buffer_load_dwordx4 v[188:191], v1, s[24:27], s58 offen offset:0 sc1
  ds_read_b128 v[36:39], v2 offset:39936
  s_waitcnt lgkmcnt(3)
  v_mfma_f32_32x32x16_bf16 v[8:23], v[228:231], v[24:27], v[8:23]
  ds_read_b128 v[24:27], v2 offset:40960
  s_waitcnt lgkmcnt(3)
  v_mfma_f32_32x32x16_bf16 v[8:23], v[232:235], v[28:31], v[8:23]
  buffer_load_dwordx4 v[192:195], v1, s[24:27], s58 offen offset:1024 sc1
  ds_read_b128 v[28:31], v2 offset:41984
  s_waitcnt lgkmcnt(3)
  v_mfma_f32_32x32x16_bf16 v[8:23], v[236:239], v[32:35], v[8:23]
  buffer_load_dwordx4 v[196:199], v1, s[24:27], s58 offen offset:2048 sc1
  ds_read_b128 v[32:35], v2 offset:43008
  s_waitcnt lgkmcnt(3)
  v_mfma_f32_32x32x16_bf16 v[8:23], v[240:243], v[36:39], v[8:23]
  ds_read_b128 v[36:39], v2 offset:44032
  s_waitcnt lgkmcnt(3)
  v_mfma_f32_32x32x16_bf16 v[8:23], v[244:247], v[24:27], v[8:23]
  buffer_load_dwordx4 v[200:203], v1, s[24:27], s58 offen offset:3072 sc1
  s_mov_b32 s58, s100
  ds_read_b128 v[24:27], v2 offset:45056
  s_waitcnt lgkmcnt(3)
  v_mfma_f32_32x32x16_bf16 v[8:23], v[248:251], v[28:31], v[8:23]
  buffer_load_dwordx4 v[204:207], v1, s[24:27], s58 offen offset:0 sc1
  ds_read_b128 v[28:31], v2 offset:46080
  s_waitcnt lgkmcnt(3)
  v_mfma_f32_32x32x16_bf16 v[8:23], v[252:255], v[32:35], v[8:23]
  ds_read_b128 v[32:35], v2 offset:47104
  s_waitcnt lgkmcnt(3)
  v_mfma_f32_32x32x16_bf16 v[8:23], v[84:87], v[36:39], v[8:23]
  buffer_load_dwordx4 v[208:211], v1, s[24:27], s58 offen offset:1024 sc1
  ds_read_b128 v[36:39], v2 offset:48128
  s_waitcnt lgkmcnt(3)
  v_mfma_f32_32x32x16_bf16 v[8:23], v[88:91], v[24:27], v[8:23]
  buffer_load_dwordx4 v[212:215], v1, s[24:27], s58 offen offset:2048 sc1
  ds_read_b128 v[24:27], v2 offset:49152
  s_waitcnt lgkmcnt(3)
  v_mfma_f32_32x32x16_bf16 v[8:23], v[92:95], v[28:31], v[8:23]
  ds_read_b128 v[28:31], v2 offset:50176
  s_waitcnt lgkmcnt(3)
  v_mfma_f32_32x32x16_bf16 v[8:23], v[96:99], v[32:35], v[8:23]
  buffer_load_dwordx4 v[216:219], v1, s[24:27], s58 offen offset:3072 sc1
  s_add_u32 s58, s58, 4096
  ds_read_b128 v[32:35], v2 offset:51200
  s_waitcnt lgkmcnt(3)
  v_mfma_f32_32x32x16_bf16 v[8:23], v[100:103], v[36:39], v[8:23]
  buffer_load_dwordx4 v[220:223], v1, s[24:27], s58 offen offset:0 sc1
  ds_read_b128 v[36:39], v2 offset:52224
  s_waitcnt lgkmcnt(3)
  v_mfma_f32_32x32x16_bf16 v[8:23], v[104:107], v[24:27], v[8:23]
  ds_read_b128 v[24:27], v2 offset:53248
  s_waitcnt lgkmcnt(3)
  v_mfma_f32_32x32x16_bf16 v[8:23], v[108:111], v[28:31], v[8:23]
  buffer_load_dwordx4 v[224:227], v1, s[24:27], s58 offen offset:1024 sc1
  ds_read_b128 v[28:31], v2 offset:54272
  s_waitcnt lgkmcnt(3)
  v_mfma_f32_32x32x16_bf16 v[8:23], v[112:115], v[32:35], v[8:23]
  buffer_load_dwordx4 v[228:231], v1, s[24:27], s58 offen offset:2048 sc1
  ds_read_b128 v[32:35], v2 offset:55296
  s_waitcnt lgkmcnt(3)
  v_mfma_f32_32x32x16_bf16 v[8:23], v[116:119], v[36:39], v[8:23]
  buffer_load_dwordx4 v[232:235], v1, s[24:27], s58 offen offset:3072 sc1
  s_add_u32 s58, s58, 4096
  ds_read_b128 v[36:39], v2 offset:56320
  s_waitcnt lgkmcnt(3) vmcnt(39)
  v_mfma_f32_32x32x16_bf16 v[8:23], v[40:43], v[24:27], v[8:23]
  ds_read_b128 v[24:27], v2 offset:57344
  s_waitcnt lgkmcnt(3) vmcnt(38)
  v_mfma_f32_32x32x16_bf16 v[8:23], v[44:47], v[28:31], v[8:23]
  buffer_load_dwordx4 v[236:239], v1, s[24:27], s58 offen offset:0 sc1
  ds_read_b128 v[28:31], v2 offset:58368
  s_waitcnt lgkmcnt(3) vmcnt(38)
  v_mfma_f32_32x32x16_bf16 v[8:23], v[48:51], v[32:35], v[8:23]
  buffer_load_dwordx4 v[240:243], v1, s[24:27], s58 offen offset:1024 sc1
  ds_read_b128 v[32:35], v2 offset:59392
  s_waitcnt lgkmcnt(3) vmcnt(38)
  v_mfma_f32_32x32x16_bf16 v[8:23], v[52:55], v[36:39], v[8:23]
  ds_read_b128 v[36:39], v2 offset:60416
  s_waitcnt lgkmcnt(3) vmcnt(37)
  v_mfma_f32_32x32x16_bf16 v[8:23], v[56:59], v[24:27], v[8:23]
  buffer_load_dwordx4 v[244:247], v1, s[24:27], s58 offen offset:2048 sc1
  ds_read_b128 v[24:27], v2 offset:61440
  s_waitcnt lgkmcnt(3) vmcnt(37)
  v_mfma_f32_32x32x16_bf16 v[8:23], v[60:63], v[28:31], v[8:23]
  buffer_load_dwordx4 v[248:251], v1, s[24:27], s58 offen offset:3072 sc1
  s_add_u32 s58, s58, 4096
  ds_read_b128 v[28:31], v2 offset:62464
  s_waitcnt lgkmcnt(3) vmcnt(37)
  v_mfma_f32_32x32x16_bf16 v[8:23], v[64:67], v[32:35], v[8:23]
  ds_read_b128 v[32:35], v2 offset:63488
  s_waitcnt lgkmcnt(3) vmcnt(36)
  v_mfma_f32_32x32x16_bf16 v[8:23], v[68:71], v[36:39], v[8:23]
  buffer_load_dwordx4 v[252:255], v1, s[24:27], s58 offen offset:0 sc1
  ds_read_b128 v[36:39], v2 offset:64512
  s_waitcnt lgkmcnt(3) vmcnt(36)
  v_mfma_f32_32x32x16_bf16 v[8:23], v[72:75], v[24:27], v[8:23]
  buffer_load_dwordx4 v[84:87], v1, s[24:27], s58 offen offset:1024 sc1
  ds_read_b128 v[24:27], v3 offset:0
  s_waitcnt lgkmcnt(3) vmcnt(36)
  v_mfma_f32_32x32x16_bf16 v[8:23], v[76:79], v[28:31], v[8:23]
  ds_read_b128 v[28:31], v3 offset:1024
  s_waitcnt lgkmcnt(3) vmcnt(35)
  v_mfma_f32_32x32x16_bf16 v[8:23], v[80:83], v[32:35], v[8:23]
  buffer_load_dwordx4 v[88:91], v1, s[24:27], s58 offen offset:2048 sc1
  ds_read_b128 v[32:35], v3 offset:2048
  s_waitcnt lgkmcnt(3) vmcnt(35)
  v_mfma_f32_32x32x16_bf16 v[8:23], v[120:123], v[36:39], v[8:23]
  buffer_load_dwordx4 v[92:95], v1, s[24:27], s58 offen offset:3072 sc1
  s_add_u32 s58, s58, 4096
  ds_read_b128 v[36:39], v3 offset:3072
  s_waitcnt lgkmcnt(3) vmcnt(35)
  v_mfma_f32_32x32x16_bf16 v[8:23], v[124:127], v[24:27], v[8:23]
  ds_read_b128 v[24:27], v3 offset:4096
  s_waitcnt lgkmcnt(3) vmcnt(34)
  v_mfma_f32_32x32x16_bf16 v[8:23], v[128:131], v[28:31], v[8:23]
  buffer_load_dwordx4 v[96:99], v1, s[24:27], s58 offen offset:0 sc1
  ds_read_b128 v[28:31], v3 offset:5120
  s_waitcnt lgkmcnt(3) vmcnt(34)
  v_mfma_f32_32x32x16_bf16 v[8:23], v[132:135], v[32:35], v[8:23]
  buffer_load_dwordx4 v[100:103], v1, s[24:27], s58 offen offset:1024 sc1
  ds_read_b128 v[32:35], v3 offset:6144
  s_waitcnt lgkmcnt(3) vmcnt(34)
  v_mfma_f32_32x32x16_bf16 v[8:23], v[136:139], v[36:39], v[8:23]
  ds_read_b128 v[36:39], v3 offset:7168
  s_waitcnt lgkmcnt(3) vmcnt(33)
  v_mfma_f32_32x32x16_bf16 v[8:23], v[140:143], v[24:27], v[8:23]
  buffer_load_dwordx4 v[104:107], v1, s[24:27], s58 offen offset:2048 sc1
  ds_read_b128 v[24:27], v3 offset:8192
  s_waitcnt lgkmcnt(3) vmcnt(33)
  v_mfma_f32_32x32x16_bf16 v[8:23], v[144:147], v[28:31], v[8:23]
  buffer_load_dwordx4 v[108:111], v1, s[24:27], s58 offen offset:3072 sc1
  s_add_u32 s58, s58, 4096
  ds_read_b128 v[28:31], v3 offset:9216
  s_waitcnt lgkmcnt(3) vmcnt(33)
  v_mfma_f32_32x32x16_bf16 v[8:23], v[148:151], v[32:35], v[8:23]
  ds_read_b128 v[32:35], v3 offset:10240
  s_waitcnt lgkmcnt(3) vmcnt(32)
  v_mfma_f32_32x32x16_bf16 v[8:23], v[152:155], v[36:39], v[8:23]
  buffer_load_dwordx4 v[112:115], v1, s[24:27], s58 offen offset:0 sc1
  ds_read_b128 v[36:39], v3 offset:11264
  s_waitcnt lgkmcnt(3) vmcnt(32)
  v_mfma_f32_32x32x16_bf16 v[8:23], v[156:159], v[24:27], v[8:23]
  buffer_load_dwordx4 v[116:119], v1, s[24:27], s58 offen offset:1024 sc1
  ds_read_b128 v[24:27], v3 offset:12288
  s_waitcnt lgkmcnt(3) vmcnt(32)
  v_mfma_f32_32x32x16_bf16 v[8:23], v[160:163], v[28:31], v[8:23]
  ds_read_b128 v[28:31], v3 offset:13312
  s_waitcnt lgkmcnt(3) vmcnt(31)
  v_mfma_f32_32x32x16_bf16 v[8:23], v[164:167], v[32:35], v[8:23]
  buffer_load_dwordx4 v[40:43], v1, s[24:27], s58 offen offset:2048 sc1
  ds_read_b128 v[32:35], v3 offset:14336
  s_waitcnt lgkmcnt(3) vmcnt(31)
  v_mfma_f32_32x32x16_bf16 v[8:23], v[168:171], v[36:39], v[8:23]
  buffer_load_dwordx4 v[44:47], v1, s[24:27], s58 offen offset:3072 sc1
  s_add_u32 s58, s58, 4096
  ds_read_b128 v[36:39], v3 offset:15360
  s_waitcnt lgkmcnt(3) vmcnt(31)
  v_mfma_f32_32x32x16_bf16 v[8:23], v[172:175], v[24:27], v[8:23]
  ds_read_b128 v[24:27], v3 offset:16384
  s_waitcnt lgkmcnt(3) vmcnt(30)
  v_mfma_f32_32x32x16_bf16 v[8:23], v[176:179], v[28:31], v[8:23]
  buffer_load_dwordx4 v[48:51], v1, s[24:27], s58 offen offset:0 sc1
  ds_read_b128 v[28:31], v3 offset:17408
  s_waitcnt lgkmcnt(3) vmcnt(30)
  v_mfma_f32_32x32x16_bf16 v[8:23], v[180:183], v[32:35], v[8:23]
  buffer_load_dwordx4 v[52:55], v1, s[24:27], s58 offen offset:1024 sc1
  ds_read_b128 v[32:35], v3 offset:18432
  s_waitcnt lgkmcnt(3) vmcnt(30)
  v_mfma_f32_32x32x16_bf16 v[8:23], v[184:187], v[36:39], v[8:23]
  ds_read_b128 v[36:39], v3 offset:19456
  s_waitcnt lgkmcnt(3) vmcnt(29)
  v_mfma_f32_32x32x16_bf16 v[8:23], v[188:191], v[24:27], v[8:23]
  buffer_load_dwordx4 v[56:59], v1, s[24:27], s58 offen offset:2048 sc1
  s_waitcnt lgkmcnt(2) vmcnt(29)
  v_mfma_f32_32x32x16_bf16 v[8:23], v[192:195], v[28:31], v[8:23]
  buffer_load_dwordx4 v[60:63], v1, s[24:27], s58 offen offset:3072 sc1
  s_add_u32 s58, s58, 4096
  s_waitcnt lgkmcnt(1) vmcnt(29)
  v_mfma_f32_32x32x16_bf16 v[8:23], v[196:199], v[32:35], v[8:23]
  s_waitcnt lgkmcnt(0) vmcnt(28)
  v_mfma_f32_32x32x16_bf16 v[8:23], v[200:203], v[36:39], v[8:23]
  buffer_load_dwordx4 v[64:67], v1, s[24:27], s58 offen offset:0 sc1
  s_nop 7
  s_nop 3
  v_pk_mul_f32 v[8:9], v[8:9], v[6:7] op_sel_hi:[1,0]
  v_pk_mul_f32 v[10:11], v[10:11], v[6:7] op_sel_hi:[1,0]
  v_pk_mul_f32 v[12:13], v[12:13], v[6:7] op_sel_hi:[1,0]
  v_pk_mul_f32 v[14:15], v[14:15], v[6:7] op_sel_hi:[1,0]
  v_pk_mul_f32 v[16:17], v[16:17], v[6:7] op_sel_hi:[1,0]
  v_pk_mul_f32 v[18:19], v[18:19], v[6:7] op_sel_hi:[1,0]
  v_pk_mul_f32 v[20:21], v[20:21], v[6:7] op_sel_hi:[1,0]
  v_pk_mul_f32 v[22:23], v[22:23], v[6:7] op_sel_hi:[1,0]
  v_add_u32 v2, 122880, v1
  s_barrier
  ds_read_b128 v[24:27], v2 offset:0
  ds_read_b128 v[28:31], v2 offset:1024
  ds_read_b128 v[32:35], v2 offset:2048
  ds_read_b128 v[36:39], v2 offset:3072
  s_waitcnt lgkmcnt(3) vmcnt(28)
  v_mfma_f32_32x32x16_bf16 v[8:23], v[204:207], v[24:27], v[8:23]
  buffer_load_dwordx4 v[68:71], v1, s[24:27], s58 offen offset:1024 sc1
  ds_read_b128 v[24:27], v2 offset:4096
  s_waitcnt lgkmcnt(3) vmcnt(28)
  v_mfma_f32_32x32x16_bf16 v[8:23], v[208:211], v[28:31], v[8:23]
  ds_read_b128 v[28:31], v2 offset:5120
  s_waitcnt lgkmcnt(3) vmcnt(27)
  v_mfma_f32_32x32x16_bf16 v[8:23], v[212:215], v[32:35], v[8:23]
  buffer_load_dwordx4 v[72:75], v1, s[24:27], s58 offen offset:2048 sc1
  ds_read_b128 v[32:35], v2 offset:6144
  s_waitcnt lgkmcnt(3) vmcnt(27)
  v_mfma_f32_32x32x16_bf16 v[8:23], v[216:219], v[36:39], v[8:23]
  buffer_load_dwordx4 v[76:79], v1, s[24:27], s58 offen offset:3072 sc1
  s_add_u32 s58, s58, 4096
  ds_read_b128 v[36:39], v2 offset:7168
  s_waitcnt lgkmcnt(3) vmcnt(27)
  v_mfma_f32_32x32x16_bf16 v[8:23], v[220:223], v[24:27], v[8:23]
  ds_read_b128 v[24:27], v2 offset:8192
  s_waitcnt lgkmcnt(3) vmcnt(26)
  v_mfma_f32_32x32x16_bf16 v[8:23], v[224:227], v[28:31], v[8:23]
  buffer_load_dwordx4 v[80:83], v1, s[24:27], s58 offen offset:0 sc1
  ds_read_b128 v[28:31], v2 offset:9216
  s_waitcnt lgkmcnt(3) vmcnt(26)
  v_mfma_f32_32x32x16_bf16 v[8:23], v[228:231], v[32:35], v[8:23]
  buffer_load_dwordx4 v[120:123], v1, s[24:27], s58 offen offset:1024 sc1
  ds_read_b128 v[32:35], v2 offset:10240
  s_waitcnt lgkmcnt(3) vmcnt(26)
  v_mfma_f32_32x32x16_bf16 v[8:23], v[232:235], v[36:39], v[8:23]
  ds_read_b128 v[36:39], v2 offset:11264
  s_waitcnt lgkmcnt(3) vmcnt(25)
  v_mfma_f32_32x32x16_bf16 v[8:23], v[236:239], v[24:27], v[8:23]
  buffer_load_dwordx4 v[124:127], v1, s[24:27], s58 offen offset:2048 sc1
  ds_read_b128 v[24:27], v2 offset:12288
  s_waitcnt lgkmcnt(3) vmcnt(25)
  v_mfma_f32_32x32x16_bf16 v[8:23], v[240:243], v[28:31], v[8:23]
  buffer_load_dwordx4 v[128:131], v1, s[24:27], s58 offen offset:3072 sc1
  s_add_u32 s58, s58, 4096
  ds_read_b128 v[28:31], v2 offset:13312
  s_waitcnt lgkmcnt(3) vmcnt(25)
  v_mfma_f32_32x32x16_bf16 v[8:23], v[244:247], v[32:35], v[8:23]
  ds_read_b128 v[32:35], v2 offset:14336
  s_waitcnt lgkmcnt(3) vmcnt(24)
  v_mfma_f32_32x32x16_bf16 v[8:23], v[248:251], v[36:39], v[8:23]
  buffer_load_dwordx4 v[132:135], v1, s[24:27], s58 offen offset:0 sc1
  ds_read_b128 v[36:39], v2 offset:15360
  s_waitcnt lgkmcnt(3) vmcnt(24)
  v_mfma_f32_32x32x16_bf16 v[8:23], v[252:255], v[24:27], v[8:23]
  buffer_load_dwordx4 v[136:139], v1, s[24:27], s58 offen offset:1024 sc1
  ds_read_b128 v[24:27], v2 offset:16384
  s_waitcnt lgkmcnt(3) vmcnt(24)
  v_mfma_f32_32x32x16_bf16 v[8:23], v[84:87], v[28:31], v[8:23]
  ds_read_b128 v[28:31], v2 offset:17408
  s_waitcnt lgkmcnt(3) vmcnt(23)
  v_mfma_f32_32x32x16_bf16 v[8:23], v[88:91], v[32:35], v[8:23]
  buffer_load_dwordx4 v[140:143], v1, s[24:27], s58 offen offset:2048 sc1
  ds_read_b128 v[32:35], v2 offset:18432
  s_waitcnt lgkmcnt(3) vmcnt(23)
  v_mfma_f32_32x32x16_bf16 v[8:23], v[92:95], v[36:39], v[8:23]
  buffer_load_dwordx4 v[144:147], v1, s[24:27], s58 offen offset:3072 sc1
  s_add_u32 s58, s58, 4096
  ds_read_b128 v[36:39], v2 offset:19456
  s_waitcnt lgkmcnt(3) vmcnt(23)
  v_mfma_f32_32x32x16_bf16 v[8:23], v[96:99], v[24:27], v[8:23]
  ds_read_b128 v[24:27], v2 offset:20480
  s_waitcnt lgkmcnt(3) vmcnt(22)
  v_mfma_f32_32x32x16_bf16 v[8:23], v[100:103], v[28:31], v[8:23]
  ds_read_b128 v[28:31], v2 offset:21504
  s_waitcnt lgkmcnt(3) vmcnt(21)
  v_mfma_f32_32x32x16_bf16 v[8:23], v[104:107], v[32:35], v[8:23]
  ds_read_b128 v[32:35], v2 offset:22528
  s_waitcnt lgkmcnt(3) vmcnt(20)
  v_mfma_f32_32x32x16_bf16 v[8:23], v[108:111], v[36:39], v[8:23]
  ds_read_b128 v[36:39], v2 offset:23552
  s_waitcnt lgkmcnt(3) vmcnt(19)
  v_mfma_f32_32x32x16_bf16 v[8:23], v[112:115], v[24:27], v[8:23]
  ds_read_b128 v[24:27], v2 offset:24576
  s_waitcnt lgkmcnt(3) vmcnt(18)
  v_mfma_f32_32x32x16_bf16 v[8:23], v[116:119], v[28:31], v[8:23]
  ds_read_b128 v[28:31], v2 offset:25600
  s_waitcnt lgkmcnt(3) vmcnt(17)
  v_mfma_f32_32x32x16_bf16 v[8:23], v[40:43], v[32:35], v[8:23]
  ds_read_b128 v[32:35], v2 offset:26624
  s_waitcnt lgkmcnt(3) vmcnt(16)
  v_mfma_f32_32x32x16_bf16 v[8:23], v[44:47], v[36:39], v[8:23]
  ds_read_b128 v[36:39], v2 offset:27648
  s_waitcnt lgkmcnt(3) vmcnt(15)
  v_mfma_f32_32x32x16_bf16 v[8:23], v[48:51], v[24:27], v[8:23]
  ds_read_b128 v[24:27], v2 offset:28672
  s_waitcnt lgkmcnt(3) vmcnt(14)
  v_mfma_f32_32x32x16_bf16 v[8:23], v[52:55], v[28:31], v[8:23]
  ds_read_b128 v[28:31], v2 offset:29696
  s_waitcnt lgkmcnt(3) vmcnt(13)
  v_mfma_f32_32x32x16_bf16 v[8:23], v[56:59], v[32:35], v[8:23]
  ds_read_b128 v[32:35], v2 offset:30720
  s_waitcnt lgkmcnt(3) vmcnt(12)
  v_mfma_f32_32x32x16_bf16 v[8:23], v[60:63], v[36:39], v[8:23]
  ds_read_b128 v[36:39], v2 offset:31744
  s_waitcnt lgkmcnt(3) vmcnt(11)
  v_mfma_f32_32x32x16_bf16 v[8:23], v[64:67], v[24:27], v[8:23]
  s_barrier
  s_lshl_b32 s52, s44, 12
  v_add_u32 v5, s52, v1
  ds_read_b128 v[24:27], v2 offset:32768
  s_waitcnt lgkmcnt(3) vmcnt(10)
  v_mfma_f32_32x32x16_bf16 v[8:23], v[68:71], v[28:31], v[8:23]
  ds_read_b128 v[28:31], v2 offset:33792
  s_waitcnt lgkmcnt(3) vmcnt(9)
  v_mfma_f32_32x32x16_bf16 v[8:23], v[72:75], v[32:35], v[8:23]
  ds_read_b128 v[32:35], v2 offset:34816
  s_waitcnt lgkmcnt(3) vmcnt(8)
  v_mfma_f32_32x32x16_bf16 v[8:23], v[76:79], v[36:39], v[8:23]
  ds_read_b128 v[36:39], v2 offset:35840
  s_waitcnt lgkmcnt(3) vmcnt(7)
  v_mfma_f32_32x32x16_bf16 v[8:23], v[80:83], v[24:27], v[8:23]
  ds_read_b128 v[148:151], v5 offset:0
  ds_read_b128 v[152:155], v5 offset:1024
  ds_read_b128 v[156:159], v5 offset:2048
  ds_read_b128 v[160:163], v5 offset:3072
  ds_read_b128 v[24:27], v2 offset:36864
  s_waitcnt lgkmcnt(7) vmcnt(6)
  v_mfma_f32_32x32x16_bf16 v[8:23], v[120:123], v[28:31], v[8:23]
  ds_read_b128 v[28:31], v2 offset:37888
  s_waitcnt lgkmcnt(7) vmcnt(5)
  v_mfma_f32_32x32x16_bf16 v[8:23], v[124:127], v[32:35], v[8:23]
  ds_read_b128 v[32:35], v2 offset:38912
  s_waitcnt lgkmcnt(7) vmcnt(4)
  v_mfma_f32_32x32x16_bf16 v[8:23], v[128:131], v[36:39], v[8:23]
  ds_read_b128 v[36:39], v2 offset:39936
  s_waitcnt lgkmcnt(3) vmcnt(3)
  v_mfma_f32_32x32x16_bf16 v[8:23], v[132:135], v[24:27], v[8:23]
  s_waitcnt lgkmcnt(2) vmcnt(2)
  v_mfma_f32_32x32x16_bf16 v[8:23], v[136:139], v[28:31], v[8:23]
  s_waitcnt lgkmcnt(1) vmcnt(1)
  v_mfma_f32_32x32x16_bf16 v[8:23], v[140:143], v[32:35], v[8:23]
  s_waitcnt lgkmcnt(0) vmcnt(0)
  v_mfma_f32_32x32x16_bf16 v[8:23], v[144:147], v[36:39], v[8:23]
  s_nop 7
  v_and_b32 v24, 31, v0
  v_mul_u32_u24 v24, 1280, v24
  v_lshrrev_b32 v25, 5, v0
  v_lshl_add_u32 v24, v25, 5, v24
  s_mul_i32 s52, s50, 40960
  s_mul_i32 s53, s51, 320
  s_add_u32 s52, s52, s53
  s_lshl_b32 s53, s44, 6
  s_add_u32 s52, s52, s53
  v_pk_add_f32 v[8:9], v[8:9], v[148:149]
  v_pk_add_f32 v[10:11], v[10:11], v[150:151]
  v_pk_add_f32 v[12:13], v[12:13], v[152:153]
  v_pk_add_f32 v[14:15], v[14:15], v[154:155]
  v_pk_add_f32 v[16:17], v[16:17], v[156:157]
  v_pk_add_f32 v[18:19], v[18:19], v[158:159]
  v_pk_add_f32 v[20:21], v[20:21], v[160:161]
  v_pk_add_f32 v[22:23], v[22:23], v[162:163]
  v_cvt_pk_bf16_f32 v28, v8, v9
  v_cvt_pk_bf16_f32 v29, v10, v11
  v_cvt_pk_bf16_f32 v30, v12, v13
  v_cvt_pk_bf16_f32 v31, v14, v15
  v_cvt_pk_bf16_f32 v32, v16, v17
  v_cvt_pk_bf16_f32 v33, v18, v19
  v_cvt_pk_bf16_f32 v34, v20, v21
  v_cvt_pk_bf16_f32 v35, v22, v23
  buffer_store_dwordx4 v[28:31], v24, s[28:31], s52 offen
  buffer_store_dwordx4 v[32:35], v24, s[28:31], s52 offen offset:16
  s_endpgm
L_small:
  s_sub_u32 s55, s44, 4
  s_mul_i32 s52, s55, 24576
  v_add_u32 v2, s52, v1
  s_lshl_b32 s52, s55, 12
  v_add_u32 v41, s52, v1
  v_lshlrev_b32 v4, 3, v0
  s_mul_i32 s52, s50, 40960
  s_add_u32 s52, s52, 0xd80000
  s_lshl_b32 s53, s55, 13
  s_add_u32 s6, s52, s53
  s_add_u32 s7, s6, 4096
  s_lshl_b32 s53, s55, 11
  s_add_u32 s8, s52, s53
  s_add_u32 s8, s8, 32768
  s_mov_b32 s10, 0
  ds_read_b128 v[24:27], v2 offset:0
  ds_read_b128 v[28:31], v2 offset:1024
  ds_read_b128 v[32:35], v2 offset:2048
  ds_read_b128 v[36:39], v2 offset:3072
  s_waitcnt lgkmcnt(3)
  v_mfma_f32_32x32x16_bf16 v[8:23], v[84:87], v[24:27], 0
  ds_read_b128 v[24:27], v2 offset:4096
  s_waitcnt lgkmcnt(3)
  v_mfma_f32_32x32x16_bf16 v[8:23], v[88:91], v[28:31], v[8:23]
  ds_read_b128 v[28:31], v2 offset:5120
  s_waitcnt lgkmcnt(3)
  v_mfma_f32_32x32x16_bf16 v[8:23], v[92:95], v[32:35], v[8:23]
  ds_read_b128 v[32:35], v2 offset:6144
  s_waitcnt lgkmcnt(3)
  v_mfma_f32_32x32x16_bf16 v[8:23], v[96:99], v[36:39], v[8:23]
  ds_read_b128 v[36:39], v2 offset:7168
  s_waitcnt lgkmcnt(3)
  v_mfma_f32_32x32x16_bf16 v[8:23], v[100:103], v[24:27], v[8:23]
  ds_read_b128 v[24:27], v2 offset:8192
  s_waitcnt lgkmcnt(3)
  v_mfma_f32_32x32x16_bf16 v[8:23], v[104:107], v[28:31], v[8:23]
  ds_read_b128 v[28:31], v2 offset:9216
  s_waitcnt lgkmcnt(3)
  v_mfma_f32_32x32x16_bf16 v[8:23], v[108:111], v[32:35], v[8:23]
  ds_read_b128 v[32:35], v2 offset:10240
  s_waitcnt lgkmcnt(3)
  v_mfma_f32_32x32x16_bf16 v[8:23], v[112:115], v[36:39], v[8:23]
  s_waitcnt vmcnt(2)
  ds_read_b128 v[56:59], v5 offset:0
  ds_read_b128 v[60:63], v5 offset:1024
  ds_read_b128 v[64:67], v5 offset:2048
  ds_read_b128 v[36:39], v2 offset:11264
  s_waitcnt lgkmcnt(6)
  v_mfma_f32_32x32x16_bf16 v[8:23], v[116:119], v[24:27], v[8:23]
  ds_read_b128 v[24:27], v2 offset:12288
  s_waitcnt lgkmcnt(6)
  v_mfma_f32_32x32x16_bf16 v[8:23], v[120:123], v[28:31], v[8:23]
  ds_read_b128 v[28:31], v2 offset:13312
  s_waitcnt lgkmcnt(6)
  v_mfma_f32_32x32x16_bf16 v[8:23], v[124:127], v[32:35], v[8:23]
  ds_read_b128 v[32:35], v2 offset:14336
  s_waitcnt lgkmcnt(3)
  v_mfma_f32_32x32x16_bf16 v[8:23], v[128:131], v[36:39], v[8:23]
  ds_read_b128 v[36:39], v2 offset:15360
  s_waitcnt lgkmcnt(3)
  v_mfma_f32_32x32x16_bf16 v[8:23], v[132:135], v[24:27], v[8:23]
  ds_read_b128 v[24:27], v2 offset:16384
  s_waitcnt lgkmcnt(3)
  v_mfma_f32_32x32x16_bf16 v[8:23], v[136:139], v[28:31], v[8:23]
  ds_read_b128 v[28:31], v2 offset:17408
  s_waitcnt lgkmcnt(3)
  v_mfma_f32_32x32x16_bf16 v[8:23], v[140:143], v[32:35], v[8:23]
  ds_read_b128 v[32:35], v2 offset:18432
  s_waitcnt lgkmcnt(3)
  v_mfma_f32_32x32x16_bf16 v[8:23], v[144:147], v[36:39], v[8:23]
  ds_read_b128 v[36:39], v2 offset:19456
  s_waitcnt lgkmcnt(3)
  v_mfma_f32_32x32x16_bf16 v[8:23], v[148:151], v[24:27], v[8:23]
  ds_read_b128 v[24:27], v2 offset:20480
  s_waitcnt lgkmcnt(3)
  v_mfma_f32_32x32x16_bf16 v[8:23], v[152:155], v[28:31], v[8:23]
  ds_read_b128 v[28:31], v2 offset:21504
  s_waitcnt lgkmcnt(3)
  v_mfma_f32_32x32x16_bf16 v[8:23], v[156:159], v[32:35], v[8:23]
  ds_read_b128 v[32:35], v2 offset:22528
  s_waitcnt lgkmcnt(3)
  v_mfma_f32_32x32x16_bf16 v[8:23], v[160:163], v[36:39], v[8:23]
  ds_read_b128 v[36:39], v2 offset:23552
  s_waitcnt lgkmcnt(3)
  v_mfma_f32_32x32x16_bf16 v[8:23], v[164:167], v[24:27], v[8:23]
  ds_read_b128 v[24:27], v3 offset:20480
  s_waitcnt lgkmcnt(3)
  v_mfma_f32_32x32x16_bf16 v[8:23], v[168:171], v[28:31], v[8:23]
  ds_read_b128 v[28:31], v3 offset:21504
  s_waitcnt lgkmcnt(3)
  v_mfma_f32_32x32x16_bf16 v[8:23], v[172:175], v[32:35], v[8:23]
  ds_read_b128 v[32:35], v3 offset:22528
  s_waitcnt lgkmcnt(3)
  v_mfma_f32_32x32x16_bf16 v[8:23], v[176:179], v[36:39], v[8:23]
  ds_read_b128 v[36:39], v3 offset:23552
  s_waitcnt lgkmcnt(3)
  v_mfma_f32_32x32x16_bf16 v[68:83], v[220:223], v[24:27], 0
  ds_read_b128 v[24:27], v3 offset:24576
  s_waitcnt lgkmcnt(3)
  v_mfma_f32_32x32x16_bf16 v[68:83], v[224:227], v[28:31], v[68:83]
  ds_read_b128 v[28:31], v3 offset:25600
  s_waitcnt lgkmcnt(3)
  v_mfma_f32_32x32x16_bf16 v[68:83], v[228:231], v[32:35], v[68:83]
  ds_read_b128 v[32:35], v3 offset:26624
  s_waitcnt lgkmcnt(3)
  v_mfma_f32_32x32x16_bf16 v[68:83], v[232:235], v[36:39], v[68:83]
  ds_read_b128 v[36:39], v3 offset:27648
  s_waitcnt lgkmcnt(3)
  v_mfma_f32_32x32x16_bf16 v[68:83], v[236:239], v[24:27], v[68:83]
  ds_read_b128 v[24:27], v3 offset:28672
  s_waitcnt lgkmcnt(3)
  v_mfma_f32_32x32x16_bf16 v[68:83], v[240:243], v[28:31], v[68:83]
  ds_read_b128 v[28:31], v3 offset:29696
  s_waitcnt lgkmcnt(3)
  v_mfma_f32_32x32x16_bf16 v[68:83], v[244:247], v[32:35], v[68:83]
  ds_read_b128 v[32:35], v3 offset:30720
  s_waitcnt lgkmcnt(3)
  v_mfma_f32_32x32x16_bf16 v[68:83], v[248:251], v[36:39], v[68:83]
  ds_read_b128 v[36:39], v3 offset:31744
  s_waitcnt lgkmcnt(3)
  v_mfma_f32_32x32x16_bf16 v[68:83], v[252:255], v[24:27], v[68:83]
  s_waitcnt lgkmcnt(2)
  v_mfma_f32_32x32x16_bf16 v[68:83], v[56:59], v[28:31], v[68:83]
  s_waitcnt lgkmcnt(1)
  v_mfma_f32_32x32x16_bf16 v[68:83], v[60:63], v[32:35], v[68:83]
  s_waitcnt lgkmcnt(0)
  v_mfma_f32_32x32x16_bf16 v[68:83], v[64:67], v[36:39], v[68:83]
  v_pk_mul_f32 v[8:9], v[8:9], v[6:7] op_sel_hi:[1,0]
  v_pk_mul_f32 v[10:11], v[10:11], v[6:7] op_sel_hi:[1,0]
  v_pk_mul_f32 v[12:13], v[12:13], v[6:7] op_sel_hi:[1,0]
  v_pk_mul_f32 v[14:15], v[14:15], v[6:7] op_sel_hi:[1,0]
  v_pk_mul_f32 v[16:17], v[16:17], v[6:7] op_sel_hi:[1,0]
  v_pk_mul_f32 v[18:19], v[18:19], v[6:7] op_sel_hi:[1,0]
  v_pk_mul_f32 v[20:21], v[20:21], v[6:7] op_sel_hi:[1,0]
  v_pk_mul_f32 v[22:23], v[22:23], v[6:7] op_sel_hi:[1,0]
  s_nop 3
  v_pk_mul_f32 v[68:69], v[68:69], v[6:7] op_sel_hi:[1,0]
  v_pk_mul_f32 v[70:71], v[70:71], v[6:7] op_sel_hi:[1,0]
  v_pk_mul_f32 v[72:73], v[72:73], v[6:7] op_sel_hi:[1,0]
  v_pk_mul_f32 v[74:75], v[74:75], v[6:7] op_sel_hi:[1,0]
  v_pk_mul_f32 v[76:77], v[76:77], v[6:7] op_sel_hi:[1,0]
  v_pk_mul_f32 v[78:79], v[78:79], v[6:7] op_sel_hi:[1,0]
  v_pk_mul_f32 v[80:81], v[80:81], v[6:7] op_sel_hi:[1,0]
  v_pk_mul_f32 v[82:83], v[82:83], v[6:7] op_sel_hi:[1,0]
  s_barrier
  ds_write_b128 v41, v[68:71] offset:0
  ds_write_b128 v41, v[72:75] offset:1024
  ds_write_b128 v41, v[76:79] offset:2048
  ds_write_b128 v41, v[80:83] offset:3072
  buffer_load_dwordx4 v[84:87], v1, s[24:27], s6 offen offset:0 sc1
  buffer_load_dwordx4 v[88:91], v1, s[24:27], s6 offen offset:1024 sc1
  buffer_load_dwordx4 v[92:95], v1, s[24:27], s6 offen offset:2048 sc1
  buffer_load_dwordx4 v[96:99], v1, s[24:27], s6 offen offset:3072 sc1
  buffer_load_dwordx4 v[100:103], v1, s[24:27], s7 offen offset:0 sc1
  buffer_load_dwordx4 v[104:107], v1, s[24:27], s7 offen offset:1024 sc1
  buffer_load_dwordx4 v[108:111], v1, s[24:27], s7 offen offset:2048 sc1
  buffer_load_dwordx4 v[112:115], v1, s[24:27], s7 offen offset:3072 sc1
  buffer_load_dwordx2 v[116:117], v4, s[24:27], s8 offen offset:0 sc1
  buffer_load_dwordx2 v[118:119], v4, s[24:27], s8 offen offset:512 sc1
  buffer_load_dwordx2 v[120:121], v4, s[24:27], s8 offen offset:1024 sc1
  buffer_load_dwordx2 v[122:123], v4, s[24:27], s8 offen offset:1536 sc1
  s_lshl_b32 s52, s55, 13
  s_add_u32 s52, s52, 122880
  v_add_u32 v42, s52, v1
  s_lshl_b32 s52, s55, 11
  s_add_u32 s52, s52, 155648
  v_add_u32 v43, s52, v1
  s_lshl_b32 s52, s55, 12
  s_add_u32 s52, s52, 98304
  v_add_u32 v3, s52, v1
L_o_spin:
  s_mov_b32 s9, 0
  s_add_u32 s10, s10, 1
  s_waitcnt vmcnt(0)
  v_max3_u32 v44, v84, v85, v86
  v_max_u32 v44, v44, v87
  v_cmp_eq_u32 vcc, -1, v44
  s_cbranch_vccnz L_o_re0
L_o_ok0:
  v_max3_u32 v44, v88, v89, v90
  v_max_u32 v44, v44, v91
  v_cmp_eq_u32 vcc, -1, v44
  s_cbranch_vccnz L_o_re1
L_o_ok1:
  v_max3_u32 v44, v92, v93, v94
  v_max_u32 v44, v44, v95
  v_cmp_eq_u32 vcc, -1, v44
  s_cbranch_vccnz L_o_re2
L_o_ok2:
  v_max3_u32 v44, v96, v97, v98
  v_max_u32 v44, v44, v99
  v_cmp_eq_u32 vcc, -1, v44
  s_cbranch_vccnz L_o_re3
L_o_ok3:
  v_max3_u32 v44, v100, v101, v102
  v_max_u32 v44, v44, v103
  v_cmp_eq_u32 vcc, -1, v44
  s_cbranch_vccnz L_o_re4
L_o_ok4:
  v_max3_u32 v44, v104, v105, v106
  v_max_u32 v44, v44, v107
  v_cmp_eq_u32 vcc, -1, v44
  s_cbranch_vccnz L_o_re5
L_o_ok5:
  v_max3_u32 v44, v108, v109, v110
  v_max_u32 v44, v44, v111
  v_cmp_eq_u32 vcc, -1, v44
  s_cbranch_vccnz L_o_re6
L_o_ok6:
  v_max3_u32 v44, v112, v113, v114
  v_max_u32 v44, v44, v115
  v_cmp_eq_u32 vcc, -1, v44
  s_cbranch_vccnz L_o_re7
L_o_ok7:
  v_max3_u32 v44, v116, v117, v118
  v_max_u32 v44, v44, v119
  v_cmp_eq_u32 vcc, -1, v44
  s_cbranch_vccnz L_o_re8
L_o_ok8:
  v_max3_u32 v44, v120, v121, v122
  v_max_u32 v44, v44, v123
  v_cmp_eq_u32 vcc, -1, v44
  s_cbranch_vccnz L_o_re9
L_o_ok9:
  s_cmp_lg_u32 s9, 0
  s_cbranch_scc1 L_o_spin
  ds_write_b128 v42, v[84:87] offset:0
  ds_write_b128 v42, v[88:91] offset:1024
  ds_write_b128 v42, v[92:95] offset:2048
  ds_write_b128 v42, v[96:99] offset:3072
  ds_write_b128 v42, v[100:103] offset:4096
  ds_write_b128 v42, v[104:107] offset:5120
  ds_write_b128 v42, v[108:111] offset:6144
  ds_write_b128 v42, v[112:115] offset:7168
  ds_write_b128 v43, v[116:119] offset:0
  ds_write_b128 v43, v[120:123] offset:1024
  v_mfma_f32_32x32x16_bf16 v[8:23], v[180:183], v[84:87], v[8:23]
  v_mfma_f32_32x32x16_bf16 v[8:23], v[184:187], v[88:91], v[8:23]
  v_mfma_f32_32x32x16_bf16 v[8:23], v[188:191], v[92:95], v[8:23]
  v_mfma_f32_32x32x16_bf16 v[8:23], v[192:195], v[96:99], v[8:23]
  v_mfma_f32_32x32x16_bf16 v[8:23], v[196:199], v[100:103], v[8:23]
  v_mfma_f32_32x32x16_bf16 v[8:23], v[200:203], v[104:107], v[8:23]
  v_mfma_f32_32x32x16_bf16 v[8:23], v[204:207], v[108:111], v[8:23]
  v_mfma_f32_32x32x16_bf16 v[8:23], v[208:211], v[112:115], v[8:23]
  v_mfma_f32_32x32x16_bf16 v[8:23], v[212:215], v[116:119], v[8:23]
  v_mfma_f32_32x32x16_bf16 v[8:23], v[216:219], v[120:123], v[8:23]
  s_lshl_b32 s52, s55, 10
  s_add_u32 s52, s52, 98304
  v_add_u32 v2, s52, v1
  v_and_b32 v24, 31, v0
  v_mul_u32_u24 v24, 1280, v24
  v_lshrrev_b32 v25, 5, v0
  v_lshl_add_u32 v24, v25, 5, v24
  s_mul_i32 s52, s50, 40960
  s_mul_i32 s53, s51, 320
  s_add_u32 s52, s52, s53
  s_lshl_b32 s53, s55, 3
  s_add_u32 s52, s52, s53
  s_add_u32 s52, s52, 256
  ds_write_b128 v3, v[8:11] offset:0
  ds_write_b128 v3, v[12:15] offset:1024
  ds_write_b128 v3, v[16:19] offset:2048
  ds_write_b128 v3, v[20:23] offset:3072
  s_waitcnt lgkmcnt(0)
  s_barrier
  ds_read_b128 v[40:43], v2 offset:0
  ds_read_b128 v[44:47], v2 offset:4096
  ds_read_b128 v[48:51], v2 offset:8192
  ds_read_b128 v[52:55], v2 offset:12288
  s_waitcnt lgkmcnt(2)
  v_add_f32 v40, v40, v44
  v_add_f32 v41, v41, v45
  v_add_f32 v42, v42, v46
  v_add_f32 v43, v43, v47
  s_waitcnt lgkmcnt(0)
  v_add_f32 v48, v48, v52
  v_add_f32 v49, v49, v53
  v_add_f32 v50, v50, v54
  v_add_f32 v51, v51, v55
  v_add_f32 v40, v40, v48
  v_add_f32 v41, v41, v49
  v_add_f32 v42, v42, v50
  v_add_f32 v43, v43, v51
  v_cvt_pk_bf16_f32 v40, v40, v41
  v_cvt_pk_bf16_f32 v41, v42, v43
  s_barrier
  buffer_store_dwordx2 v[40:41], v24, s[28:31], s52 offen
L_end:
  s_endpgm
L_o_re0:
  s_cmp_le_u32 s10, 30000
  s_cbranch_scc0 L_o_ok0
  s_mov_b32 s9, 1
  buffer_load_dwordx4 v[84:87], v1, s[24:27], s6 offen offset:0 sc1
  s_branch L_o_ok0
L_o_re1:
  s_cmp_le_u32 s10, 30000
  s_cbranch_scc0 L_o_ok1
  s_mov_b32 s9, 1
  buffer_load_dwordx4 v[88:91], v1, s[24:27], s6 offen offset:1024 sc1
  s_branch L_o_ok1
L_o_re2:
  s_cmp_le_u32 s10, 30000
  s_cbranch_scc0 L_o_ok2
  s_mov_b32 s9, 1
  buffer_load_dwordx4 v[92:95], v1, s[24:27], s6 offen offset:2048 sc1
  s_branch L_o_ok2
L_o_re3:
  s_cmp_le_u32 s10, 30000
  s_cbranch_scc0 L_o_ok3
  s_mov_b32 s9, 1
  buffer_load_dwordx4 v[96:99], v1, s[24:27], s6 offen offset:3072 sc1
  s_branch L_o_ok3
L_o_re4:
  s_cmp_le_u32 s10, 30000
  s_cbranch_scc0 L_o_ok4
  s_mov_b32 s9, 1
  buffer_load_dwordx4 v[100:103], v1, s[24:27], s7 offen offset:0 sc1
  s_branch L_o_ok4
L_o_re5:
  s_cmp_le_u32 s10, 30000
  s_cbranch_scc0 L_o_ok5
  s_mov_b32 s9, 1
  buffer_load_dwordx4 v[104:107], v1, s[24:27], s7 offen offset:1024 sc1
  s_branch L_o_ok5
L_o_re6:
  s_cmp_le_u32 s10, 30000
  s_cbranch_scc0 L_o_ok6
  s_mov_b32 s9, 1
  buffer_load_dwordx4 v[108:111], v1, s[24:27], s7 offen offset:2048 sc1
  s_branch L_o_ok6
L_o_re7:
  s_cmp_le_u32 s10, 30000
  s_cbranch_scc0 L_o_ok7
  s_mov_b32 s9, 1
  buffer_load_dwordx4 v[112:115], v1, s[24:27], s7 offen offset:3072 sc1
  s_branch L_o_ok7
L_o_re8:
  s_cmp_le_u32 s10, 30000
  s_cbranch_scc0 L_o_ok8
  s_mov_b32 s9, 1
  buffer_load_dwordx2 v[116:117], v4, s[24:27], s8 offen offset:0 sc1
  buffer_load_dwordx2 v[118:119], v4, s[24:27], s8 offen offset:512 sc1
  s_branch L_o_ok8
L_o_re9:
  s_cmp_le_u32 s10, 30000
  s_cbranch_scc0 L_o_ok9
  s_mov_b32 s9, 1
  buffer_load_dwordx2 v[120:121], v4, s[24:27], s8 offen offset:1024 sc1
  buffer_load_dwordx2 v[122:123], v4, s[24:27], s8 offen offset:1536 sc1
  s_branch L_o_ok9
L_rdy_spin:
  buffer_load_dword v255, off, s[36:39], 0 sc1
  s_add_u32 s53, s53, 1
  s_waitcnt vmcnt(0)
  v_readfirstlane_b32 s52, v255
  s_cmp_gt_u32 s53, 30000
  s_cbranch_scc1 L_rdy
  s_cmp_eq_u32 s52, 0
  s_cbranch_scc1 L_rdy_spin
  s_branch L_rdy
L_wsp0:
  ds_read_b32 v4, v2 offset:4
  s_waitcnt lgkmcnt(0)
  v_readfirstlane_b32 s52, v4
  s_cmp_lg_u32 s52, 4
  s_cbranch_scc1 L_wsp0
  s_branch L_wsd0
L_wsp1:
  ds_read_b32 v4, v2 offset:8
  s_waitcnt lgkmcnt(0)
  v_readfirstlane_b32 s52, v4
  s_cmp_lg_u32 s52, 4
  s_cbranch_scc1 L_wsp1
  s_branch L_wsd1
L_wsp2:
  ds_read_b32 v4, v2 offset:12
  s_waitcnt lgkmcnt(0)
  v_readfirstlane_b32 s52, v4
  s_cmp_lg_u32 s52, 4
  s_cbranch_scc1 L_wsp2
  s_branch L_wsd2
L_c_spin:
  s_mov_b32 s55, 0
L_c_spin2:
  buffer_load_dword v7, off, s[24:27], s16 sc1
  s_add_u32 s55, s55, 1
  s_waitcnt vmcnt(0)
  v_readfirstlane_b32 s53, v7
  s_cmp_gt_u32 s55, 30000
  s_cbranch_scc1 L_c_ok
  s_cmp_lt_u32 s53, 32
  s_cbranch_scc1 L_c_spin2
  s_branch L_c_ok
L_h_spin:
  s_mov_b32 s55, 0
  s_mov_b64 exec, 0xffff
L_h_spin2:
  v_lshlrev_b32 v7, 11, v0
  s_add_u32 s55, s55, 1
  buffer_load_dword v7, v7, s[24:27], s54 offen sc1
  s_waitcnt vmcnt(0)
  v_cmp_gt_u32 vcc, 16, v7
  s_cmp_gt_u32 s55, 30000
  s_cbranch_scc1 L_h_out
  s_cbranch_vccnz L_h_spin2
L_h_out:
  s_mov_b64 exec, -1
  s_branch L_h_ok
L_slow:
  v_mov_b32 v32, v10
  v_mov_b32 v33, v11
  s_mul_i32 s6, s48, 1280
  s_add_u32 s6, s6, 0x280000
  s_mul_i32 s7, s48, 320
  s_add_u32 s7, s7, 0x500000
  v_subrev_u32 v26, 122880, v2
  v_lshrrev_b32 v28, 5, v0
  v_mul_u32_u24 v28, 10240, v28
  v_lshl_add_u32 v27, v8, 4, v28
  v_add_u32 v28, 20480, v27
  v_and_b32 v29, 0xff, v26
  v_mov_b32 v24, 0xff800000
  s_mov_b32 s8, 0
  s_not_b64 exec, s[62:63]
  v_mov_b32 v80, 0
  s_mov_b64 exec, -1
  v_mov_b32 v40, 0
  v_mov_b32 v41, 0
  v_mov_b32 v42, 0
  v_mov_b32 v43, 0
  v_mov_b32 v44, 0
  v_mov_b32 v45, 0
  v_mov_b32 v46, 0
  v_mov_b32 v47, 0
  v_mov_b32 v48, 0
  v_mov_b32 v49, 0
  v_mov_b32 v50, 0
  v_mov_b32 v51, 0
  v_mov_b32 v52, 0
  v_mov_b32 v53, 0
  v_mov_b32 v54, 0
  v_mov_b32 v55, 0
L_sloop:
  buffer_load_dwordx2 v[76:77], v26, s[24:27], s6 offen sc1
  buffer_load_dwordx2 v[78:79], v26, s[24:27], s6 offen offset:512 sc1
  buffer_load_dwordx2 v[82:83], v29, s[24:27], s6 offen offset:1024 sc1
  s_mov_b64 exec, s[60:61]
  buffer_load_dwordx4 v[56:59], v27, s[24:27], s7 offen sc1
  buffer_load_dwordx4 v[60:63], v28, s[24:27], s7 offen sc1
  s_mov_b64 exec, -1
  s_add_u32 s6, s6, 40960
  s_add_u32 s7, s7, 40960
  s_waitcnt vmcnt(0)
  v_mfma_f32_32x32x16_bf16 v[8:23], v[76:79], v[72:75], 0
  v_mfma_f32_32x32x8_bf16 v[8:23], v[82:83], v[80:81], v[8:23]
  s_nop 11
  v_max3_f32 v30, v8, v9, v24
  v_max3_f32 v30, v30, v10, v11
  v_max3_f32 v30, v30, v12, v13
  v_max3_f32 v30, v30, v14, v15
  v_max3_f32 v30, v30, v16, v17
  v_max3_f32 v30, v30, v18, v19
  v_max3_f32 v30, v30, v20, v21
  v_max3_f32 v30, v30, v22, v23
  v_mov_b32 v31, v30
  s_nop 1
  v_permlane32_swap_b32 v30, v31
  s_nop 0
  v_max_f32 v30, v30, v31
  v_sub_f32 v25, v24, v30
  v_exp_f32 v25, v25
  v_mov_b32 v24, v30
  v_sub_f32 v8, v8, v30
  v_mul_f32 v40, v40, v25
  v_sub_f32 v9, v9, v30
  v_mul_f32 v41, v41, v25
  v_sub_f32 v10, v10, v30
  v_mul_f32 v42, v42, v25
  v_sub_f32 v11, v11, v30
  v_mul_f32 v43, v43, v25
  v_sub_f32 v12, v12, v30
  v_mul_f32 v44, v44, v25
  v_sub_f32 v13, v13, v30
  v_mul_f32 v45, v45, v25
  v_sub_f32 v14, v14, v30
  v_mul_f32 v46, v46, v25
  v_sub_f32 v15, v15, v30
  v_mul_f32 v47, v47, v25
  v_sub_f32 v16, v16, v30
  v_mul_f32 v48, v48, v25
  v_sub_f32 v17, v17, v30
  v_mul_f32 v49, v49, v25
  v_sub_f32 v18, v18, v30
  v_mul_f32 v50, v50, v25
  v_sub_f32 v19, v19, v30
  v_mul_f32 v51, v51, v25
  v_sub_f32 v20, v20, v30
  v_mul_f32 v52, v52, v25
  v_sub_f32 v21, v21, v30
  v_mul_f32 v53, v53, v25
  v_sub_f32 v22, v22, v30
  v_mul_f32 v54, v54, v25
  v_sub_f32 v23, v23, v30
  v_mul_f32 v55, v55, v25
  v_exp_f32 v8, v8
  v_exp_f32 v9, v9
  v_exp_f32 v10, v10
  v_exp_f32 v11, v11
  v_exp_f32 v12, v12
  v_exp_f32 v13, v13
  v_exp_f32 v14, v14
  v_exp_f32 v15, v15
  v_exp_f32 v16, v16
  v_exp_f32 v17, v17
  v_exp_f32 v18, v18
  v_exp_f32 v19, v19
  v_exp_f32 v20, v20
  v_exp_f32 v21, v21
  v_exp_f32 v22, v22
  v_exp_f32 v23, v23
  s_nop 1
  v_smfmac_f32_32x32x32_bf16 v[40:55], v[56:59], v[8:15], v4
  v_smfmac_f32_32x32x32_bf16 v[40:55], v[60:63], v[16:23], v4
  s_add_u32 s8, s8, 1
  s_cmp_lg_u32 s8, 64
  s_nop 11
  s_cbranch_scc1 L_sloop
  v_cndmask_b32 v12, v48, v52, s[62:63]
  v_mov_b32 v10, v32
  v_mov_b32 v11, v33
  v_rcp_f32 v13, v12
L_last:
  s_branch L_store
.section .rodata,"a"
.p2align 6
.amdhsa_kernel gated_mix__mha_block__dense_activation_relu__prompt_kernel
  .amdhsa_next_free_vgpr 256
  .amdhsa_next_free_sgpr 102
  .amdhsa_accum_offset 256
  .amdhsa_group_segment_fixed_size 0
  .amdhsa_kernarg_size 80
  .amdhsa_user_sgpr_count 2
  .amdhsa_user_sgpr_kernarg_segment_ptr 1
  .amdhsa_system_sgpr_workgroup_id_x 1
.end_amdhsa_kernel
```
